```python
import torch

def _softmax(x, axis=-1):
    return torch.softmax(x, dim=axis)
def _gelu(x):
    return torch.nn.functional.gelu(x, approximate="tanh")
def _silu(x):
    return torch.nn.functional.silu(x)
def _sigmoid(x):
    return torch.sigmoid(x)
def _layernorm(x, axis=-1, eps=1e-5):
    m = x.mean(dim=axis, keepdim=True)
    v = x.var(dim=axis, keepdim=True, unbiased=False)
    return (x - m) / torch.sqrt(v + eps)
def _scatter_add(tgt, idx, src, axis=0):
    return tgt.clone().index_add_(axis, idx, src)
def _segment_sum(src, seg, n):
    out = torch.zeros((n,) + src.shape[1:], dtype=src.dtype)
    return out.index_add_(0, seg, src)
def _pad(x, pw):
    flat = tuple(v for pair in reversed(pw) for v in pair)
    return torch.nn.functional.pad(x, flat)

kernel_name = 'gated_mix__ssm_conv_s5__swiglu_ffn__prompt'

def setup_inputs():

    _w = (lambda a: (lambda t: t.to(torch.bfloat16) if t.is_floating_point() else t)(torch.as_tensor(a)))
    def _A_setup():
        B, S, D = 1, 2048, 512
        P = D
        Lambda_re = -0.5 * (lambda _x: torch.exp(torch.as_tensor(_x)))((lambda *s: torch.randn(*s, dtype=torch.bfloat16) * 0.2)(P))
        Lambda_im = (lambda *s: torch.randn(*s, dtype=torch.bfloat16) * 0.4)(P) * 1.0
        B_re = (lambda *s: torch.randn(*s, dtype=torch.bfloat16) * 0.2)(P, D) * (D ** -0.5)
        B_im = (lambda *s: torch.randn(*s, dtype=torch.bfloat16) * 0.2)(P, D) * (D ** -0.5)
        C_re = (lambda *s: torch.randn(*s, dtype=torch.bfloat16) * 0.2)(D, P) * (P ** -0.5)
        C_im = (lambda *s: torch.randn(*s, dtype=torch.bfloat16) * 0.2)(D, P) * (P ** -0.5)
        log_dt = (lambda *s: torch.randn(*s, dtype=torch.bfloat16) * 0.2)(P) * 0.3 - 2.0
        Dskip = (lambda *s: torch.randn(*s, dtype=torch.bfloat16) * 0.05)(D)
        return {
            "x": _w((lambda *s: torch.randn(*s, dtype=torch.bfloat16) * 0.05)(B, S, D)),
            "Lambda_re": _w(Lambda_re),
            "Lambda_im": _w(Lambda_im),
            "B_re": _w(B_re),
            "B_im": _w(B_im),
            "C_re": _w(C_re),
            "C_im": _w(C_im),
            "log_dt": _w(log_dt),
            "Dskip": _w(Dskip),
        }
    _A_in = _A_setup()

    def _B_setup():
        B, S, D, F = 1, 2048, 512, 1792
        return {
            "x": _w((lambda *s: torch.randn(*s, dtype=torch.bfloat16) * 0.05)(B, S, D)),
            "w_gate": _w((lambda *s: torch.randn(*s, dtype=torch.bfloat16) * 0.05)(D, F)),
            "w_up": _w((lambda *s: torch.randn(*s, dtype=torch.bfloat16) * 0.05)(D, F)),
            "w_down": _w((lambda *s: torch.randn(*s, dtype=torch.bfloat16) * 0.05)(F, D)),
        }
    _B_in = _B_setup()

    return {
        "A_x": _A_in["x"],
        "A_Lambda_re": _A_in["Lambda_re"],
        "A_Lambda_im": _A_in["Lambda_im"],
        "A_B_re": _A_in["B_re"],
        "A_B_im": _A_in["B_im"],
        "A_C_re": _A_in["C_re"],
        "A_C_im": _A_in["C_im"],
        "A_log_dt": _A_in["log_dt"],
        "A_Dskip": _A_in["Dskip"],
        "B_x": _B_in["x"],
        "B_w_gate": _B_in["w_gate"],
        "B_w_up": _B_in["w_up"],
        "B_w_down": _B_in["w_down"],
        "gate_w": _w((lambda *s: torch.randn(*s, dtype=torch.bfloat16) * 0.05)(512) * 16.0),
    }

def reference(A_x, A_Lambda_re, A_Lambda_im, A_B_re, A_B_im, A_C_re, A_C_im, A_log_dt, A_Dskip, B_x, B_w_gate, B_w_up, B_w_down, gate_w):
    def _A_ref(x, Lambda_re, Lambda_im, B_re, B_im, C_re, C_im, log_dt, Dskip):
        Bsz, L, H = x.shape
        Lam = Lambda_re + 1j * Lambda_im
        Bmat = B_re + 1j * B_im
        Cmat = C_re + 1j * C_im
        dt = torch.exp(log_dt)
        Lam_bar = torch.exp(dt * Lam)
        B_bar = ((Lam_bar - 1.0) / Lam)[:, None] * Bmat
        Bu = torch.einsum("bld,pd->blp", x + 0j, B_bar)
        h = torch.zeros_like(Bu[:, 0, :])
        hs = []
        for t in range(L):
            h = Lam_bar[None, :] * h + Bu[:, t, :]
            hs.append(h)
        hseq = torch.stack(hs, 1)
        y = 2.0 * torch.einsum("blp,dp->bld", hseq, Cmat).real + x * Dskip[None, None, :]
        return y

    def _B_ref(x, w_gate, w_up, w_down):
        g = _silu(x @ w_gate)
        u = x @ w_up
        return (g * u) @ w_down

    x = A_x
    g = _sigmoid((x * gate_w).sum(-1, keepdims=True))
    a = _A_ref(x, A_Lambda_re, A_Lambda_im, A_B_re, A_B_im, A_C_re, A_C_im, A_log_dt, A_Dskip)
    b = _B_ref(x, B_w_gate, B_w_up, B_w_down)
    return g * a + (1 - g) * b
```

```asm
; @launch kernel=fused_kernel grid=(256,1,1) block=(256,1,1) lds=163840
.amdgcn_target "amdgcn-amd-amdhsa--gfx950"
.text
.globl fused_kernel
.p2align 8
.type fused_kernel,@function
fused_kernel:
    s_cmp_ge_u32 s2, 256
    s_cbranch_scc1 fused_kernel_end
    s_load_dwordx16 s[4:19], s[0:1], 0
    s_load_dwordx8 s[20:27], s[0:1], 80
    s_load_dwordx4 s[28:31], s[0:1], 120
    s_load_dwordx2 s[76:77], s[0:1], 112
    s_load_dwordx2 s[78:79], s[0:1], 64
    s_memrealtime s[100:101]
    s_cmp_ge_u32 s2, 16
    s_cbranch_scc1 fused_kernel_nocpf
    s_getpc_b64 s[70:71]
fused_kernel_pc0:
    v_lshlrev_b32 v97, 7, v0
    v_min_u32 v97, fused_kernel_codeend-fused_kernel_pc0-4, v97
    global_load_dword v245, v97, s[70:71]
fused_kernel_nocpf:
    v_lshrrev_b32 v96, 6, v0
    v_and_b32 v209, 63, v0
    v_readfirstlane_b32 s64, v96
    s_and_b32 s70, s2, 7
    s_lshr_b32 s71, s2, 3
    s_and_b32 s67, s70, 1
    s_lshl_b32 s67, s67, 3
    s_and_b32 s72, s71, 7
    s_add_u32 s67, s67, s72
    s_lshr_b32 s68, s70, 1
    s_lshl_b32 s68, s68, 2
    s_lshr_b32 s72, s71, 3
    s_add_u32 s68, s68, s72
    s_lshl_b32 s69, s68, 1
    s_add_u32 s69, s69, s67
    s_lshl_b32 s48, s70, 2
    s_and_b32 s72, s71, 3
    s_add_u32 s48, s48, s72
    s_lshr_b32 s49, s71, 2
    s_lshr_b32 s65, s64, 1
    s_and_b32 s66, s64, 1
    s_mul_i32 s3, s68, 112
    s_add_u32 s63, s3, 63
    s_and_b32 s63, s63, 0xffffffc0
    s_and_b32 s74, s69, 7
    s_lshl_b32 s74, s74, 7
    s_mul_i32 s75, s74, 1792
    s_lshl_b32 s60, s64, 12
    s_lshl_b32 s61, s64, 11
    s_add_u32 s61, s61, 16384
    v_lshrrev_b32 v96, 3, v209
    v_and_b32 v97, 7, v209
    v_lshrrev_b32 v98, 4, v209
    v_xor_b32 v98, v98, v97
    v_lshlrev_b32 v98, 4, v98
    v_xor_b32 v99, 64, v98
    v_lshrrev_b32 v100, 5, v209
    v_lshlrev_b32 v100, 4, v100
    v_and_b32 v101, 3, v96
    s_lshl_b32 s70, s67, 7
    s_lshl_b32 s71, s64, 5
    s_add_u32 s70, s70, s71
    v_add3_u32 v100, v100, v101, s70
    v_lshlrev_b32 v100, 10, v100
    v_add_u32 v196, v100, v98
    v_add_u32 v197, v100, v99
    v_add_u32 v197, 3072, v197
    v_add_u32 v198, v100, v98
    v_add_u32 v198, 6144, v198
    v_add_u32 v199, v100, v99
    v_add_u32 v199, 9216, v199
    s_lshl_b32 s70, s68, 5
    s_lshl_b32 s71, s65, 4
    s_add_u32 s70, s70, s71
    v_add_u32 v100, s70, v96
    v_lshlrev_b32 v100, 10, v100
    v_add_u32 v200, v100, v98
    v_add_u32 v201, v100, v99
    v_add_u32 v201, 7168, v201
    s_lshl_b32 s70, s66, 5
    v_add_u32 v100, s70, v96
    v_mul_u32_u24 v100, 3584, v100
    v_bfe_u32 v101, v209, 1, 2
    v_bfe_u32 v102, v209, 4, 1
    v_xor_b32 v101, v101, v102
    s_lshl_b32 s70, s65, 1
    v_xor_b32 v101, s70, v101
    v_lshl_add_u32 v100, v101, 5, v100
    v_and_b32 v101, 1, v209
    v_lshl_add_u32 v100, v101, 4, v100
    s_lshl_b32 s70, s63, 1
    v_add_u32 v202, s70, v100
    v_add_u32 v203, 27648, v202
    v_add_u32 v204, 55296, v202
    v_add_u32 v205, 82944, v202
    s_waitcnt lgkmcnt(0)
    s_mov_b32 s32, s4
    s_mov_b32 s33, s5
    s_mov_b32 s34, 2097152
    s_mov_b32 s35, 0x20000
    s_or_b32 s70, s2, s64
    s_cbranch_scc1 fused_kernel_nonon
    s_or_b32 s70, s100, 1
    v_mov_b32 v112, s70
    v_mov_b32 v113, s101
    v_mov_b32 v114, 0
    global_store_dwordx2 v114, v[112:113], s[28:29] sc1
fused_kernel_nonon:
    s_add_u32 m0, s60, 0
    s_nop 0
    buffer_load_dwordx4 v196, s[32:35], s74 offen lds
    buffer_load_dwordx4 v197, s[32:35], s74 offen offset:1024 lds
    buffer_load_dwordx4 v198, s[32:35], s74 offen offset:2048 lds
    buffer_load_dwordx4 v199, s[32:35], s74 offen offset:3072 lds
    s_cmp_eq_u32 s66, 0
    s_cselect_b32 s36, s10, s12
    s_cselect_b32 s37, s11, s13
    s_mov_b32 s38, 524288
    s_mov_b32 s39, 0x20000
    s_add_u32 m0, s61, 0
    s_nop 0
    buffer_load_dwordx4 v200, s[36:39], s74 offen lds
    buffer_load_dwordx4 v201, s[36:39], s74 offen offset:1024 lds
    s_cmp_eq_u32 s65, 0
    s_cselect_b32 s40, s20, s22
    s_cselect_b32 s41, s21, s23
    s_mov_b32 s42, 1835008
    s_mov_b32 s43, 0x20000
    s_add_u32 m0, s60, 24576
    s_nop 0
    buffer_load_dwordx4 v202, s[40:43], s75 offen lds
    buffer_load_dwordx4 v203, s[40:43], s75 offen offset:1024 lds
    buffer_load_dwordx4 v204, s[40:43], s75 offen offset:2048 lds
    buffer_load_dwordx4 v205, s[40:43], s75 offen offset:3072 lds
    v_and_b32 v96, 31, v209
    v_lshrrev_b32 v97, 5, v209
    v_bfe_u32 v98, v209, 1, 3
    v_xor_b32 v98, v98, v97
    v_lshlrev_b32 v98, 4, v98
    v_lshl_add_u32 v98, v96, 7, v98
    s_lshl_b32 s70, s65, 13
    s_lshl_b32 s71, s66, 12
    s_add_u32 s70, s70, s71
    s_add_u32 s71, s71, 16384
    s_add_u32 s74, s74, 128
    s_and_b32 s74, s74, 1023
    s_mul_i32 s75, s74, 1792
    s_add_u32 m0, s60, 40960
    s_nop 0
    buffer_load_dwordx4 v196, s[32:35], s74 offen lds
    buffer_load_dwordx4 v197, s[32:35], s74 offen offset:1024 lds
    v_xor_b32 v100, 0, v98
    v_add_u32 v168, s70, v100
    v_xor_b32 v172, 0x1000, v168
    v_add_u32 v184, s71, v100
    buffer_load_dwordx4 v198, s[32:35], s74 offen offset:2048 lds
    v_add_u32 v176, 81920, v168
    v_add_u32 v180, 81920, v172
    v_add_u32 v188, 81920, v184
    buffer_load_dwordx4 v199, s[32:35], s74 offen offset:3072 lds
    v_xor_b32 v100, 32, v98
    v_add_u32 v169, s70, v100
    v_xor_b32 v173, 0x1000, v169
    v_add_u32 v185, s71, v100
    s_add_u32 m0, s61, 40960
    s_nop 0
    buffer_load_dwordx4 v200, s[36:39], s74 offen lds
    v_add_u32 v177, 81920, v169
    v_add_u32 v181, 81920, v173
    v_add_u32 v189, 81920, v185
    buffer_load_dwordx4 v201, s[36:39], s74 offen offset:1024 lds
    v_xor_b32 v100, 64, v98
    v_add_u32 v170, s70, v100
    v_xor_b32 v174, 0x1000, v170
    v_add_u32 v186, s71, v100
    s_add_u32 m0, s60, 65536
    s_nop 0
    buffer_load_dwordx4 v202, s[40:43], s75 offen lds
    v_add_u32 v178, 81920, v170
    v_add_u32 v182, 81920, v174
    v_add_u32 v190, 81920, v186
    buffer_load_dwordx4 v203, s[40:43], s75 offen offset:1024 lds
    v_xor_b32 v100, 96, v98
    v_add_u32 v171, s70, v100
    v_xor_b32 v175, 0x1000, v171
    v_add_u32 v187, s71, v100
    buffer_load_dwordx4 v204, s[40:43], s75 offen offset:2048 lds
    v_add_u32 v179, 81920, v171
    v_add_u32 v183, 81920, v175
    v_add_u32 v191, 81920, v187
    buffer_load_dwordx4 v205, s[40:43], s75 offen offset:3072 lds
    v_bfe_u32 v104, v209, 4, 1
    v_bfe_u32 v105, v209, 2, 2
    v_lshl_add_u32 v105, v97, 3, v105
    v_and_b32 v106, 3, v209
    v_lshlrev_b32 v106, 3, v106
    v_bfe_u32 v102, v209, 3, 2
    s_lshl_b32 s70, s66, 1
    v_xor_b32 v102, s70, v102
    v_lshl_add_u32 v102, v102, 5, v106
    v_lshl_add_u32 v102, v105, 7, v102
    v_lshl_add_u32 v102, v104, 13, v102
    v_add_u32 v192, 24576, v102
    v_xor_b32 v193, 32, v192
    v_add_u32 v194, 81920, v192
    v_add_u32 v195, 81920, v193
    s_lshl_b32 s70, s68, 5
    s_lshl_b32 s71, s66, 4
    s_add_u32 s70, s70, s71
    v_and_b32 v100, 15, v209
    v_add_lshl_u32 v100, v100, s70, 1
    global_load_ushort v108, v100, s[6:7]
    global_load_ushort v109, v100, s[8:9]
    global_load_ushort v110, v100, s[18:19]
    s_mov_b32 s56, s24
    s_mov_b32 s57, s25
    s_mov_b32 s58, 1835008
    s_mov_b32 s59, 0x20000
    s_lshr_b32 s70, s48, 1
    s_mul_i32 s70, s70, 7
    s_and_b32 s71, s48, 1
    s_lshl_b32 s71, s71, 2
    s_add_u32 s71, s71, s64
    s_add_u32 s18, s70, s71
    s_cmp_eq_u32 s71, 7
    s_cselect_b32 s18, 0x4000, s18
    s_lshl_b32 s70, s18, 4
    v_lshrrev_b32 v100, 3, v209
    v_add_lshl_u32 v100, v100, s70, 10
    v_and_b32 v101, 7, v209
    v_lshl_add_u32 v100, v101, 4, v100
    s_lshl_b32 s70, s49, 7
    v_add_u32 v246, s70, v100
    v_add_u32 v247, 7168, v246
    s_lshr_b32 s70, s48, 2
    s_lshl_b32 s70, s70, 2
    s_add_u32 s70, s70, s64
    s_bfe_u32 s71, s48, 0x10001
    s_lshl_b32 s72, s70, 1
    s_add_u32 s72, s72, s71
    s_cmp_eq_u32 s71, 0
    s_cselect_b32 s8, s14, s16
    s_cselect_b32 s9, s15, s17
    s_and_b32 s71, s48, 1
    s_lshl_b32 s73, s49, 1
    s_add_u32 s73, s73, s71
    s_lshl_b32 s71, s73, 5
    v_add_lshl_u32 v100, v96, s71, 10
    v_lshl_add_u32 v100, v97, 4, v100
    s_lshl_b32 s70, s70, 5
    v_add_u32 v248, s70, v100
    s_add_u32 m0, s61, 139264
    s_nop 0
    buffer_load_dwordx4 v246, s[56:59], 0 offen lds
    buffer_load_dwordx4 v247, s[56:59], 0 offen offset:1024 lds
    global_load_dwordx4 v[128:131], v248, s[8:9]
    s_lshl_b32 s70, s67, 7
    s_lshl_b32 s71, s68, 3
    s_add_u32 s70, s70, s71
    s_lshl_b32 s71, s64, 1
    s_add_u32 s14, s70, s71
    s_lshl_b32 s70, s14, 10
    v_lshlrev_b32 v229, 4, v209
    buffer_load_dwordx4 v[132:135], v229, s[32:35], s70 offen
    buffer_load_dwordx4 v[136:139], v229, s[32:35], s70 offen offset:1024
    global_load_dwordx4 v[140:143], v229, s[26:27]
    s_waitcnt vmcnt(19)
    s_barrier
    ds_read_b128 a[0:3], v168 offset:0
    ds_read_b128 v[144:147], v184 offset:0
    ds_read_b128 a[128:131], v172 offset:0
    ds_read_b64_tr_b16 v[148:149], v192 offset:0
    ds_read_b64_tr_b16 v[150:151], v192 offset:512
    ds_read_b64_tr_b16 v[152:153], v193 offset:0
    ds_read_b64_tr_b16 v[154:155], v193 offset:512
    s_waitcnt lgkmcnt(4)
    v_mfma_f32_32x32x16_bf16 v[0:15], a[0:3], v[144:147], 0
    s_add_u32 s74, s74, 128
    s_and_b32 s74, s74, 1023
    s_mul_i32 s75, s74, 1792
    s_add_u32 m0, s60, 81920
    ds_read_b128 a[4:7], v169 offset:0
    ds_read_b128 v[156:159], v185 offset:0
    ds_read_b128 a[132:135], v173 offset:0
    v_mfma_f32_32x32x16_bf16 v[16:31], a[128:131], v[144:147], 0
    buffer_load_dwordx4 v196, s[32:35], s74 offen lds
    ds_read_b64_tr_b16 v[160:161], v192 offset:2048
    ds_read_b64_tr_b16 v[162:163], v192 offset:2560
    s_waitcnt lgkmcnt(5)
    v_mfma_f32_32x32x16_bf16 v[32:47], v[148:151], a[0:3], 0
    ds_read_b64_tr_b16 v[164:165], v193 offset:2048
    ds_read_b64_tr_b16 v[166:167], v193 offset:2560
    s_lshr_b32 s70, s73, 1
    s_mul_i32 s70, s70, 176
    s_add_u32 s70, s70, s72
    v_mfma_f32_32x32x16_bf16 v[48:63], v[148:151], a[128:131], 0
    buffer_load_dwordx4 v197, s[32:35], s74 offen offset:1024 lds
    s_lshl_b32 s70, s70, 1
    s_and_b32 s71, s73, 1
    v_mfma_f32_32x32x16_bf16 v[64:79], v[152:155], a[0:3], 0
    s_add_u32 s70, s70, s71
    s_lshl_b32 s70, s70, 10
    s_add_u32 s70, s70, 11534336
    v_add_u32 v126, s70, v229
    s_mov_b32 s44, s30
    v_mfma_f32_32x32x16_bf16 v[80:95], v[152:155], a[128:131], 0
    buffer_load_dwordx4 v198, s[32:35], s74 offen offset:2048 lds
    s_mov_b32 s45, s31
    s_waitcnt lgkmcnt(4)
    v_mfma_f32_32x32x16_bf16 v[0:15], a[4:7], v[156:159], v[0:15]
    ds_read_b128 a[8:11], v170 offset:0
    ds_read_b128 v[144:147], v186 offset:0
    ds_read_b128 a[136:139], v174 offset:0
    s_mov_b32 s46, 14811136
    s_mov_b32 s47, 0x20000
    v_mfma_f32_32x32x16_bf16 v[16:31], a[132:135], v[156:159], v[16:31]
    buffer_load_dwordx4 v199, s[32:35], s74 offen offset:3072 lds
    s_add_u32 m0, s61, 81920
    ds_read_b64_tr_b16 v[148:149], v192 offset:4096
    ds_read_b64_tr_b16 v[150:151], v192 offset:4608
    s_waitcnt lgkmcnt(5)
    v_mfma_f32_32x32x16_bf16 v[32:47], v[160:163], a[4:7], v[32:47]
    ds_read_b64_tr_b16 v[152:153], v193 offset:4096
    ds_read_b64_tr_b16 v[154:155], v193 offset:4608
    s_lshl_b32 s70, s68, 13
    s_add_u32 s70, s70, 14483456
    s_add_u32 s52, s30, s70
    s_addc_u32 s53, s31, 0
    v_mfma_f32_32x32x16_bf16 v[48:63], v[160:163], a[132:135], v[48:63]
    buffer_load_dwordx4 v200, s[36:39], s74 offen lds
    s_mov_b32 s54, 8192
    s_mov_b32 s55, 0x20000
    v_mfma_f32_32x32x16_bf16 v[64:79], v[164:167], a[4:7], v[64:79]
    s_mul_i32 s70, s49, 360448
    s_add_u32 s70, s70, 11534336
    s_lshl_b32 s71, s66, 10
    s_add_u32 s70, s70, s71
    v_add_u32 v206, s70, v229
    v_mfma_f32_32x32x16_bf16 v[80:95], v[164:167], a[132:135], v[80:95]
    buffer_load_dwordx4 v201, s[36:39], s74 offen offset:1024 lds
    s_add_u32 m0, s60, 106496
    s_waitcnt lgkmcnt(4)
    v_mfma_f32_32x32x16_bf16 v[0:15], a[8:11], v[144:147], v[0:15]
    ds_read_b128 a[12:15], v171 offset:0
    ds_read_b128 v[156:159], v187 offset:0
    ds_read_b128 a[140:143], v175 offset:0
    v_xor_b32 v207, 0x400, v206
    v_bfe_u32 v102, v209, 2, 2
    v_mfma_f32_32x32x16_bf16 v[16:31], a[136:139], v[144:147], v[16:31]
    buffer_load_dwordx4 v202, s[40:43], s75 offen lds
    ds_read_b64_tr_b16 v[160:161], v192 offset:6144
    ds_read_b64_tr_b16 v[162:163], v192 offset:6656
    s_waitcnt lgkmcnt(5)
    v_mfma_f32_32x32x16_bf16 v[32:47], v[148:151], a[8:11], v[32:47]
    ds_read_b64_tr_b16 v[164:165], v193 offset:6144
    ds_read_b64_tr_b16 v[166:167], v193 offset:6656
    v_lshl_add_u32 v102, v97, 2, v102
    v_lshl_add_u32 v102, v102, 7, v106
    v_lshl_add_u32 v102, v104, 5, v102
    v_mfma_f32_32x32x16_bf16 v[48:63], v[148:151], a[136:139], v[48:63]
    buffer_load_dwordx4 v203, s[40:43], s75 offen offset:1024 lds
    s_lshl_b32 s70, s64, 11
    s_add_u32 s70, s70, 155648
    v_mfma_f32_32x32x16_bf16 v[64:79], v[152:155], a[8:11], v[64:79]
    v_add_u32 v127, s70, v102
    s_and_b32 s72, s68, 3
    v_subrev_u32 v237, 24576, v192
    v_subrev_u32 v238, 24576, v193
    v_subrev_u32 v239, 24576, v194
    v_mfma_f32_32x32x16_bf16 v[80:95], v[152:155], a[136:139], v[80:95]
    buffer_load_dwordx4 v204, s[40:43], s75 offen offset:2048 lds
    v_subrev_u32 v240, 24576, v195
    s_waitcnt lgkmcnt(4)
    v_mfma_f32_32x32x16_bf16 v[0:15], a[12:15], v[156:159], v[0:15]
    s_waitcnt vmcnt(18)
    s_waitcnt lgkmcnt(0)
    s_barrier
    ds_read_b128 a[16:19], v168 offset:40960
    ds_read_b128 v[144:147], v184 offset:40960
    ds_read_b128 a[144:147], v172 offset:40960
    s_mov_b32 s73, -128
    s_cmp_lt_u32 s72, 2
    s_cselect_b32 s73, 128, s73
    v_mfma_f32_32x32x16_bf16 v[16:31], a[140:143], v[156:159], v[16:31]
    buffer_load_dwordx4 v205, s[40:43], s75 offen offset:3072 lds
    s_add_u32 s74, s74, 128
    s_and_b32 s74, s74, 1023
    s_mul_i32 s75, s74, 1792
    s_add_u32 m0, s60, 0
    ds_read_b64_tr_b16 v[148:149], v192 offset:40960
    ds_read_b64_tr_b16 v[150:151], v192 offset:41472
    v_mfma_f32_32x32x16_bf16 v[32:47], v[160:163], a[12:15], v[32:47]
    ds_read_b64_tr_b16 v[152:153], v193 offset:40960
    ds_read_b64_tr_b16 v[154:155], v193 offset:41472
    v_add_u32 v241, s73, v202
    v_add_u32 v242, s73, v203
    v_add_u32 v243, s73, v204
    v_mfma_f32_32x32x16_bf16 v[48:63], v[160:163], a[140:143], v[48:63]
    buffer_load_dwordx4 v196, s[32:35], s74 offen lds
    v_add_u32 v244, s73, v205
    v_bfe_u32 v100, v209, 2, 1
    v_mfma_f32_32x32x16_bf16 v[64:79], v[164:167], a[12:15], v[64:79]
    v_lshlrev_b32 v100, 4, v100
    v_bfe_u32 v101, v209, 3, 2
    v_lshl_add_u32 v100, v101, 2, v100
    v_and_b32 v101, 35, v209
    v_add_u32 v100, v100, v101
    v_mfma_f32_32x32x16_bf16 v[80:95], v[164:167], a[140:143], v[80:95]
    buffer_load_dwordx4 v197, s[32:35], s74 offen offset:1024 lds
    s_lshl_b32 s70, s67, 1
    s_waitcnt lgkmcnt(4)
    v_mfma_f32_32x32x16_bf16 v[0:15], a[16:19], v[144:147], v[0:15]
    ds_read_b128 a[20:23], v169 offset:40960
    ds_read_b128 v[156:159], v185 offset:40960
    ds_read_b128 a[148:151], v173 offset:40960
    s_add_u32 s70, s70, s65
    s_mul_i32 s15, s70, 360448
    v_mfma_f32_32x32x16_bf16 v[16:31], a[144:147], v[144:147], v[16:31]
    buffer_load_dwordx4 v198, s[32:35], s74 offen offset:2048 lds
    ds_read_b64_tr_b16 v[160:161], v192 offset:43008
    ds_read_b64_tr_b16 v[162:163], v192 offset:43520
    s_waitcnt lgkmcnt(5)
    v_mfma_f32_32x32x16_bf16 v[32:47], v[148:151], a[16:19], v[32:47]
    ds_read_b64_tr_b16 v[164:165], v193 offset:43008
    ds_read_b64_tr_b16 v[166:167], v193 offset:43520
    s_lshl_b32 s71, s66, 10
    s_add_u32 s70, s15, s71
    v_lshl_add_u32 v224, v100, 4, s70
    v_mfma_f32_32x32x16_bf16 v[48:63], v[148:151], a[144:147], v[48:63]
    buffer_load_dwordx4 v199, s[32:35], s74 offen offset:3072 lds
    s_add_u32 m0, s61, 0
    v_xor_b32 v225, 0x400, v224
    v_mfma_f32_32x32x16_bf16 v[64:79], v[152:155], a[16:19], v[64:79]
    s_lshl_b32 s70, s66, 5
    s_add_u32 s70, s70, s63
    s_lshl_b32 s70, s70, 7
    s_add_u32 s13, s70, 131072
    s_lshl_b32 s73, s73, 6
    v_mfma_f32_32x32x16_bf16 v[80:95], v[152:155], a[144:147], v[80:95]
    buffer_load_dwordx4 v200, s[36:39], s74 offen lds
    s_add_u32 s11, s13, s73
    s_waitcnt lgkmcnt(4)
    v_mfma_f32_32x32x16_bf16 v[0:15], a[20:23], v[156:159], v[0:15]
    ds_read_b128 a[24:27], v170 offset:40960
    ds_read_b128 v[144:147], v186 offset:40960
    ds_read_b128 a[152:155], v174 offset:40960
    s_add_u32 s70, s72, s66
    s_cmp_eq_u32 s70, 2
    s_cselect_b32 s11, 0x4000000, s11
    v_mfma_f32_32x32x16_bf16 v[16:31], a[148:151], v[156:159], v[16:31]
    buffer_load_dwordx4 v201, s[36:39], s74 offen offset:1024 lds
    s_add_u32 m0, s60, 24576
    ds_read_b64_tr_b16 v[148:149], v192 offset:45056
    ds_read_b64_tr_b16 v[150:151], v192 offset:45568
    s_waitcnt lgkmcnt(5)
    v_mfma_f32_32x32x16_bf16 v[32:47], v[160:163], a[20:23], v[32:47]
    ds_read_b64_tr_b16 v[152:153], v193 offset:45056
    ds_read_b64_tr_b16 v[154:155], v193 offset:45568
    v_mov_b32 v105, 0
    global_load_dwordx2 v[106:107], v105, s[28:29] sc1
    v_mfma_f32_32x32x16_bf16 v[48:63], v[160:163], a[148:151], v[48:63]
    buffer_load_dwordx4 v202, s[40:43], s75 offen lds
    s_waitcnt vmcnt(21)
    buffer_store_dwordx4 v[128:131], v126, s[44:47], 0 offen sc1
    v_mfma_f32_32x32x16_bf16 v[64:79], v[164:167], a[20:23], v[64:79]
    ds_read_b64_tr_b16 v[96:97], v127 offset:0
    ds_read_b64_tr_b16 v[98:99], v127 offset:1024
    ds_read_b64_tr_b16 v[100:101], v127 offset:64
    ds_read_b64_tr_b16 v[102:103], v127 offset:1088
    s_mul_i32 s20, s49, 360448
    v_mfma_f32_32x32x16_bf16 v[80:95], v[164:167], a[148:151], v[80:95]
    buffer_load_dwordx4 v203, s[40:43], s75 offen offset:1024 lds
    s_lshl_b32 s21, s18, 11
    s_waitcnt lgkmcnt(8)
    v_mfma_f32_32x32x16_bf16 v[0:15], a[24:27], v[144:147], v[0:15]
    ds_read_b128 a[28:31], v171 offset:40960
    ds_read_b128 v[156:159], v187 offset:40960
    ds_read_b128 a[156:159], v175 offset:40960
    s_add_u32 s20, s20, s21
    s_add_u32 s20, s20, 11665408
    v_mfma_f32_32x32x16_bf16 v[16:31], a[152:155], v[144:147], v[16:31]
    buffer_load_dwordx4 v204, s[40:43], s75 offen offset:2048 lds
    ds_read_b64_tr_b16 v[160:161], v192 offset:47104
    ds_read_b64_tr_b16 v[162:163], v192 offset:47616
    s_waitcnt lgkmcnt(9)
    v_mfma_f32_32x32x16_bf16 v[32:47], v[148:151], a[24:27], v[32:47]
    ds_read_b64_tr_b16 v[164:165], v193 offset:47104
    ds_read_b64_tr_b16 v[166:167], v193 offset:47616
    s_waitcnt lgkmcnt(9)
    buffer_store_dwordx4 v[96:99], v229, s[44:47], s20 offen sc1
    v_mfma_f32_32x32x16_bf16 v[48:63], v[148:151], a[152:155], v[48:63]
    buffer_load_dwordx4 v205, s[40:43], s75 offen offset:3072 lds
    s_waitcnt lgkmcnt(7)
    buffer_store_dwordx4 v[100:103], v229, s[44:47], s20 offen offset:1024 sc1
    v_mfma_f32_32x32x16_bf16 v[64:79], v[152:155], a[24:27], v[64:79]
    v_lshlrev_b32 v108, 16, v108
    v_lshlrev_b32 v109, 16, v109
    v_lshlrev_b32 v110, 16, v110
    v_mul_f32 v110, 0x3fb8aa3b, v110
    v_exp_f32 v110, v110
    v_mfma_f32_32x32x16_bf16 v[80:95], v[152:155], a[152:155], v[80:95]
    v_cvt_pk_bf16_f32 v110, v110, v110
    v_lshlrev_b32 v110, 16, v110
    v_mul_f32 v112, v110, v108
    s_waitcnt lgkmcnt(4)
    v_mfma_f32_32x32x16_bf16 v[0:15], a[28:31], v[156:159], v[0:15]
    s_waitcnt vmcnt(14)
    s_waitcnt lgkmcnt(0)
    s_barrier
    s_add_u32 s74, s74, 128
    s_and_b32 s74, s74, 1023
    s_mul_i32 s75, s74, 1792
    s_add_u32 m0, s60, 40960
    ds_read_b128 a[32:35], v176 offset:0
    ds_read_b128 v[144:147], v188 offset:0
    ds_read_b128 a[160:163], v180 offset:0
    v_mfma_f32_32x32x16_bf16 v[16:31], a[156:159], v[156:159], v[16:31]
    buffer_load_dwordx4 v196, s[32:35], s74 offen lds
    ds_read_b64_tr_b16 v[148:149], v194 offset:0
    ds_read_b64_tr_b16 v[150:151], v194 offset:512
    v_mfma_f32_32x32x16_bf16 v[32:47], v[160:163], a[28:31], v[32:47]
    buffer_load_dwordx4 v197, s[32:35], s74 offen offset:1024 lds
    ds_read_b64_tr_b16 v[152:153], v195 offset:0
    ds_read_b64_tr_b16 v[154:155], v195 offset:512
    v_mul_f32 v113, v110, v109
    v_mfma_f32_32x32x16_bf16 v[48:63], v[160:163], a[156:159], v[48:63]
    buffer_load_dwordx4 v198, s[32:35], s74 offen offset:2048 lds
    v_mul_f32 v112, 0x3fb8aa3b, v112
    v_exp_f32 v112, v112
    v_mfma_f32_32x32x16_bf16 v[64:79], v[164:167], a[28:31], v[64:79]
    v_mul_f32 v113, 0x3e22f983, v113
    v_rndne_f32 v114, v113
    v_sub_f32 v113, v113, v114
    v_cos_f32 v114, v113
    v_mfma_f32_32x32x16_bf16 v[80:95], v[164:167], a[156:159], v[80:95]
    buffer_load_dwordx4 v199, s[32:35], s74 offen offset:3072 lds
    s_add_u32 m0, s61, 40960
    s_waitcnt lgkmcnt(4)
    v_mfma_f32_32x32x16_bf16 v[0:15], a[32:35], v[144:147], v[0:15]
    ds_read_b128 a[36:39], v177 offset:0
    ds_read_b128 v[156:159], v189 offset:0
    ds_read_b128 a[164:167], v181 offset:0
    v_sin_f32 v115, v113
    v_mfma_f32_32x32x16_bf16 v[16:31], a[160:163], v[144:147], v[16:31]
    buffer_load_dwordx4 v200, s[36:39], s74 offen lds
    ds_read_b64_tr_b16 v[160:161], v194 offset:2048
    ds_read_b64_tr_b16 v[162:163], v194 offset:2560
    s_waitcnt lgkmcnt(5)
    v_mfma_f32_32x32x16_bf16 v[32:47], v[148:151], a[32:35], v[32:47]
    ds_read_b64_tr_b16 v[164:165], v195 offset:2048
    ds_read_b64_tr_b16 v[166:167], v195 offset:2560
    v_mul_f32 v210, v112, v114
    v_mul_f32 v211, v112, v115
    v_mul_f32 v112, v108, v108
    v_mfma_f32_32x32x16_bf16 v[48:63], v[148:151], a[160:163], v[48:63]
    buffer_load_dwordx4 v201, s[36:39], s74 offen offset:1024 lds
    s_add_u32 m0, s60, 65536
    v_fma_f32 v112, v109, v109, v112
    v_mfma_f32_32x32x16_bf16 v[64:79], v[152:155], a[32:35], v[64:79]
    v_rcp_f32 v112, v112
    v_add_f32 v113, -1.0, v210
    v_mul_f32 v114, v113, v108
    v_fma_f32 v114, v211, v109, v114
    v_mfma_f32_32x32x16_bf16 v[80:95], v[152:155], a[160:163], v[80:95]
    buffer_load_dwordx4 v202, s[40:43], s75 offen lds
    v_mul_f32 v115, v211, v108
    s_waitcnt lgkmcnt(4)
    v_mfma_f32_32x32x16_bf16 v[0:15], a[36:39], v[156:159], v[0:15]
    ds_read_b128 a[40:43], v178 offset:0
    ds_read_b128 v[144:147], v190 offset:0
    ds_read_b128 a[168:171], v182 offset:0
    v_fma_f32 v115, -v113, v109, v115
    v_mul_f32 v218, v114, v112
    v_mfma_f32_32x32x16_bf16 v[16:31], a[164:167], v[156:159], v[16:31]
    buffer_load_dwordx4 v203, s[40:43], s75 offen offset:1024 lds
    ds_read_b64_tr_b16 v[148:149], v194 offset:4096
    ds_read_b64_tr_b16 v[150:151], v194 offset:4608
    s_waitcnt lgkmcnt(5)
    v_mfma_f32_32x32x16_bf16 v[32:47], v[160:163], a[36:39], v[32:47]
    ds_read_b64_tr_b16 v[152:153], v195 offset:4096
    ds_read_b64_tr_b16 v[154:155], v195 offset:4608
    v_mul_f32 v219, v115, v112
    v_mul_f32 v112, v211, v211
    v_mul_f32 v113, v210, v211
    v_mfma_f32_32x32x16_bf16 v[48:63], v[160:163], a[164:167], v[48:63]
    buffer_load_dwordx4 v204, s[40:43], s75 offen offset:2048 lds
    v_fma_f32 v116, v210, v210, -v112
    v_add_f32 v117, v113, v113
    v_mfma_f32_32x32x16_bf16 v[64:79], v[164:167], a[36:39], v[64:79]
    v_mul_f32 v112, v117, v117
    v_mul_f32 v113, v116, v117
    v_fma_f32 v118, v116, v116, -v112
    v_add_f32 v119, v113, v113
    v_mul_f32 v112, v119, v119
    v_mfma_f32_32x32x16_bf16 v[80:95], v[164:167], a[164:167], v[80:95]
    buffer_load_dwordx4 v205, s[40:43], s75 offen offset:3072 lds
    s_add_u32 s17, s69, 0
    s_and_b32 s17, s17, 7
    s_mul_i32 s62, s17, 229376
    s_add_u32 m0, s60, 122880
    s_waitcnt lgkmcnt(4)
    v_mfma_f32_32x32x16_bf16 v[0:15], a[40:43], v[144:147], v[0:15]
    ds_read_b128 a[44:47], v179 offset:0
    ds_read_b128 v[156:159], v191 offset:0
    ds_read_b128 a[172:175], v183 offset:0
    v_mul_f32 v113, v118, v119
    v_fma_f32 v116, v118, v118, -v112
    v_mfma_f32_32x32x16_bf16 v[16:31], a[168:171], v[144:147], v[16:31]
    buffer_load_dwordx4 v241, s[40:43], s62 offen lds
    ds_read_b64_tr_b16 v[160:161], v194 offset:6144
    ds_read_b64_tr_b16 v[162:163], v194 offset:6656
    s_waitcnt lgkmcnt(5)
    v_mfma_f32_32x32x16_bf16 v[32:47], v[148:151], a[40:43], v[32:47]
    ds_read_b64_tr_b16 v[164:165], v195 offset:6144
    ds_read_b64_tr_b16 v[166:167], v195 offset:6656
    v_add_f32 v117, v113, v113
    v_mul_f32 v112, v117, v117
    v_mul_f32 v113, v116, v117
    v_mfma_f32_32x32x16_bf16 v[48:63], v[148:151], a[168:171], v[48:63]
    buffer_load_dwordx4 v242, s[40:43], s62 offen offset:1024 lds
    v_fma_f32 v212, v116, v116, -v112
    v_add_f32 v213, v113, v113
    v_mfma_f32_32x32x16_bf16 v[64:79], v[152:155], a[40:43], v[64:79]
    v_mul_f32 v112, v213, v213
    v_mul_f32 v113, v212, v213
    v_fma_f32 v116, v212, v212, -v112
    v_add_f32 v117, v113, v113
    v_mul_f32 v112, v117, v117
    v_mfma_f32_32x32x16_bf16 v[80:95], v[152:155], a[168:171], v[80:95]
    buffer_load_dwordx4 v243, s[40:43], s62 offen offset:2048 lds
    v_mul_f32 v113, v116, v117
    s_waitcnt lgkmcnt(4)
    v_mfma_f32_32x32x16_bf16 v[0:15], a[44:47], v[156:159], v[0:15]
    s_waitcnt vmcnt(14)
    s_waitcnt lgkmcnt(0)
    s_barrier
    s_add_u32 s74, s74, 128
    s_and_b32 s74, s74, 1023
    s_mul_i32 s75, s74, 1792
    s_add_u32 m0, s60, 81920
    ds_read_b128 a[48:51], v168 offset:0
    ds_read_b128 v[144:147], v184 offset:0
    ds_read_b128 a[176:179], v172 offset:0
    v_mfma_f32_32x32x16_bf16 v[16:31], a[172:175], v[156:159], v[16:31]
    buffer_load_dwordx4 v196, s[32:35], s74 offen lds
    ds_read_b64_tr_b16 v[148:149], v192 offset:0
    ds_read_b64_tr_b16 v[150:151], v192 offset:512
    v_mfma_f32_32x32x16_bf16 v[32:47], v[160:163], a[44:47], v[32:47]
    ds_read_b64_tr_b16 v[152:153], v193 offset:0
    ds_read_b64_tr_b16 v[154:155], v193 offset:512
    v_fma_f32 v118, v116, v116, -v112
    v_add_f32 v119, v113, v113
    v_mul_f32 v112, v119, v119
    v_mfma_f32_32x32x16_bf16 v[48:63], v[160:163], a[172:175], v[48:63]
    buffer_load_dwordx4 v197, s[32:35], s74 offen offset:1024 lds
    v_mul_f32 v113, v118, v119
    v_fma_f32 v122, v118, v118, -v112
    v_mfma_f32_32x32x16_bf16 v[64:79], v[164:167], a[44:47], v[64:79]
    v_add_f32 v123, v113, v113
    v_mul_f32 v112, v123, v123
    v_mul_f32 v113, v122, v123
    v_fma_f32 v124, v122, v122, -v112
    v_add_f32 v125, v113, v113
    v_mfma_f32_32x32x16_bf16 v[80:95], v[164:167], a[172:175], v[80:95]
    buffer_load_dwordx4 v198, s[32:35], s74 offen offset:2048 lds
    v_mul_f32 v112, v125, v125
    s_waitcnt lgkmcnt(4)
    v_mfma_f32_32x32x16_bf16 v[0:15], a[48:51], v[144:147], v[0:15]
    ds_read_b128 a[52:55], v169 offset:0
    ds_read_b128 v[156:159], v185 offset:0
    ds_read_b128 a[180:183], v173 offset:0
    v_mul_f32 v113, v124, v125
    v_fma_f32 v214, v124, v124, -v112
    v_mfma_f32_32x32x16_bf16 v[16:31], a[176:179], v[144:147], v[16:31]
    buffer_load_dwordx4 v199, s[32:35], s74 offen offset:3072 lds
    s_add_u32 m0, s61, 81920
    ds_read_b64_tr_b16 v[160:161], v192 offset:2048
    ds_read_b64_tr_b16 v[162:163], v192 offset:2560
    s_waitcnt lgkmcnt(5)
    v_mfma_f32_32x32x16_bf16 v[32:47], v[148:151], a[48:51], v[32:47]
    ds_read_b64_tr_b16 v[164:165], v193 offset:2048
    ds_read_b64_tr_b16 v[166:167], v193 offset:2560
    v_add_f32 v215, v113, v113
    v_bfe_u32 v112, v209, 4, 1
    v_xor_b32 v112, s66, v112
    v_mfma_f32_32x32x16_bf16 v[48:63], v[148:151], a[176:179], v[48:63]
    buffer_load_dwordx4 v200, s[36:39], s74 offen lds
    v_lshrrev_b32 v113, 5, v209
    v_lshl_add_u32 v231, v112, 1, v113
    v_mfma_f32_32x32x16_bf16 v[64:79], v[152:155], a[48:51], v[64:79]
    s_lshl_b32 s20, s65, 2
    v_add_u32 v231, s20, v231
    v_and_b32 v112, 1, v231
    v_cmp_eq_u32 vcc, 1, v112
    v_mov_b32 v113, 1.0
    v_mfma_f32_32x32x16_bf16 v[80:95], v[152:155], a[176:179], v[80:95]
    buffer_load_dwordx4 v201, s[36:39], s74 offen offset:1024 lds
    s_add_u32 m0, s60, 106496
    s_waitcnt lgkmcnt(4)
    v_mfma_f32_32x32x16_bf16 v[0:15], a[52:55], v[156:159], v[0:15]
    ds_read_b128 a[56:59], v170 offset:0
    ds_read_b128 v[144:147], v186 offset:0
    ds_read_b128 a[184:187], v174 offset:0
    v_mov_b32 v114, 0
    v_cndmask_b32 v216, v113, v212, vcc
    v_mfma_f32_32x32x16_bf16 v[16:31], a[180:183], v[156:159], v[16:31]
    buffer_load_dwordx4 v202, s[40:43], s75 offen lds
    ds_read_b64_tr_b16 v[148:149], v192 offset:4096
    ds_read_b64_tr_b16 v[150:151], v192 offset:4608
    s_waitcnt lgkmcnt(5)
    v_mfma_f32_32x32x16_bf16 v[32:47], v[160:163], a[52:55], v[32:47]
    ds_read_b64_tr_b16 v[152:153], v193 offset:4096
    ds_read_b64_tr_b16 v[154:155], v193 offset:4608
    v_cndmask_b32 v217, v114, v213, vcc
    v_and_b32 v112, 2, v231
    v_cmp_eq_u32 vcc, 2, v112
    v_mfma_f32_32x32x16_bf16 v[48:63], v[160:163], a[180:183], v[48:63]
    buffer_load_dwordx4 v203, s[40:43], s75 offen offset:1024 lds
    v_cndmask_b32 v116, v113, v116, vcc
    v_cndmask_b32 v117, v114, v117, vcc
    v_mfma_f32_32x32x16_bf16 v[64:79], v[164:167], a[52:55], v[64:79]
    v_and_b32 v112, 4, v231
    v_cmp_eq_u32 vcc, 4, v112
    s_nop 1
    v_cndmask_b32 v118, v113, v118, vcc
    v_cndmask_b32 v119, v114, v119, vcc
    v_mfma_f32_32x32x16_bf16 v[80:95], v[164:167], a[180:183], v[80:95]
    buffer_load_dwordx4 v204, s[40:43], s75 offen offset:2048 lds
    v_mul_f32 v120, v216, v116
    s_waitcnt lgkmcnt(4)
    v_mfma_f32_32x32x16_bf16 v[0:15], a[56:59], v[144:147], v[0:15]
    ds_read_b128 a[60:63], v171 offset:0
    ds_read_b128 v[156:159], v187 offset:0
    ds_read_b128 a[188:191], v175 offset:0
    v_mul_f32 v121, v216, v117
    v_fma_f32 v120, -v217, v117, v120
    v_mfma_f32_32x32x16_bf16 v[16:31], a[184:187], v[144:147], v[16:31]
    buffer_load_dwordx4 v205, s[40:43], s75 offen offset:3072 lds
    s_add_u32 m0, s60, 122880
    ds_read_b64_tr_b16 v[160:161], v192 offset:6144
    ds_read_b64_tr_b16 v[162:163], v192 offset:6656
    s_waitcnt lgkmcnt(5)
    v_mfma_f32_32x32x16_bf16 v[32:47], v[148:151], a[56:59], v[32:47]
    ds_read_b64_tr_b16 v[164:165], v193 offset:6144
    ds_read_b64_tr_b16 v[166:167], v193 offset:6656
    v_fma_f32 v217, v217, v116, v121
    v_mov_b32 v216, v120
    v_mul_f32 v120, v216, v118
    v_mfma_f32_32x32x16_bf16 v[48:63], v[148:151], a[184:187], v[48:63]
    buffer_load_dwordx4 v244, s[40:43], s62 offen offset:3072 lds
    s_add_u32 s17, s69, 1
    s_and_b32 s17, s17, 7
    s_mul_i32 s62, s17, 229376
    s_add_u32 m0, s60, 139264
    v_mfma_f32_32x32x16_bf16 v[64:79], v[152:155], a[56:59], v[64:79]
    v_mul_f32 v121, v216, v119
    v_fma_f32 v120, -v217, v119, v120
    v_fma_f32 v217, v217, v118, v121
    v_mov_b32 v216, v120
    v_and_b32 v112, 16, v209
    v_mfma_f32_32x32x16_bf16 v[80:95], v[152:155], a[184:187], v[80:95]
    buffer_load_dwordx4 v241, s[40:43], s62 offen lds
    v_cmp_eq_u32 vcc, 16, v112
    s_waitcnt lgkmcnt(4)
    v_mfma_f32_32x32x16_bf16 v[0:15], a[60:63], v[156:159], v[0:15]
    s_waitcnt vmcnt(15)
    s_waitcnt lgkmcnt(0)
    s_barrier
    s_add_u32 s74, s74, 128
    s_and_b32 s74, s74, 1023
    s_mul_i32 s75, s74, 1792
    s_add_u32 m0, s60, 0
    ds_read_b128 a[64:67], v168 offset:40960
    ds_read_b128 v[144:147], v184 offset:40960
    ds_read_b128 a[192:195], v172 offset:40960
    v_mfma_f32_32x32x16_bf16 v[16:31], a[188:191], v[156:159], v[16:31]
    buffer_load_dwordx4 v196, s[32:35], s74 offen lds
    ds_read_b64_tr_b16 v[148:149], v192 offset:40960
    ds_read_b64_tr_b16 v[150:151], v192 offset:41472
    v_mfma_f32_32x32x16_bf16 v[32:47], v[160:163], a[60:63], v[32:47]
    ds_read_b64_tr_b16 v[152:153], v193 offset:40960
    ds_read_b64_tr_b16 v[154:155], v193 offset:41472
    v_and_b32 v112, 32, v209
    v_cndmask_b32 v220, v113, v122, vcc
    v_cndmask_b32 v221, v114, v123, vcc
    v_mfma_f32_32x32x16_bf16 v[48:63], v[160:163], a[188:191], v[48:63]
    buffer_load_dwordx4 v197, s[32:35], s74 offen offset:1024 lds
    v_cmp_eq_u32 vcc, 32, v112
    s_nop 1
    v_cndmask_b32 v124, v113, v124, vcc
    v_mfma_f32_32x32x16_bf16 v[64:79], v[164:167], a[60:63], v[64:79]
    v_cndmask_b32 v125, v114, v125, vcc
    v_mul_f32 v120, v220, v124
    v_mul_f32 v121, v220, v125
    v_fma_f32 v120, -v221, v125, v120
    v_fma_f32 v221, v221, v124, v121
    v_mfma_f32_32x32x16_bf16 v[80:95], v[164:167], a[188:191], v[80:95]
    buffer_load_dwordx4 v198, s[32:35], s74 offen offset:2048 lds
    v_mov_b32 v220, v120
    s_waitcnt lgkmcnt(4)
    v_mfma_f32_32x32x16_bf16 v[0:15], a[64:67], v[144:147], v[0:15]
    ds_read_b128 a[68:71], v169 offset:40960
    ds_read_b128 v[156:159], v185 offset:40960
    ds_read_b128 a[196:199], v173 offset:40960
    v_and_b32 v112, 15, v209
    s_lshl_b32 s20, s66, 7
    v_mfma_f32_32x32x16_bf16 v[16:31], a[192:195], v[144:147], v[16:31]
    buffer_load_dwordx4 v199, s[32:35], s74 offen offset:3072 lds
    s_add_u32 m0, s61, 0
    ds_read_b64_tr_b16 v[160:161], v192 offset:43008
    ds_read_b64_tr_b16 v[162:163], v192 offset:43520
    s_waitcnt lgkmcnt(5)
    v_mfma_f32_32x32x16_bf16 v[32:47], v[148:151], a[64:67], v[32:47]
    ds_read_b64_tr_b16 v[164:165], v193 offset:43008
    ds_read_b64_tr_b16 v[166:167], v193 offset:43520
    v_lshl_add_u32 v112, v112, 3, s20
    v_add_u32 v227, 155648, v112
    v_lshl_add_u32 v226, v231, 8, v227
    v_mfma_f32_32x32x16_bf16 v[48:63], v[148:151], a[192:195], v[48:63]
    buffer_load_dwordx4 v200, s[36:39], s74 offen lds
    s_sub_u32 s20, 15, s67
    s_lshl_b32 s20, s20, 9
    v_mfma_f32_32x32x16_bf16 v[64:79], v[152:155], a[64:67], v[64:79]
    v_lshl_add_u32 v113, v112, 1, s20
    v_mov_b32 v114, 0x10000
    v_cmp_eq_u32 vcc, 0, v231
    v_add_u32 v230, 512, v113
    v_lshrrev_b32 v115, 4, v209
    v_mfma_f32_32x32x16_bf16 v[80:95], v[152:155], a[192:195], v[80:95]
    buffer_load_dwordx4 v201, s[36:39], s74 offen offset:1024 lds
    s_add_u32 m0, s60, 24576
    s_waitcnt lgkmcnt(4)
    v_mfma_f32_32x32x16_bf16 v[0:15], a[68:71], v[156:159], v[0:15]
    ds_read_b128 a[72:75], v170 offset:40960
    ds_read_b128 v[144:147], v186 offset:40960
    ds_read_b128 a[200:203], v174 offset:40960
    v_lshl_add_u32 v230, v115, 9, v230
    v_add_u32 v208, 4096, v230
    v_mfma_f32_32x32x16_bf16 v[16:31], a[196:199], v[156:159], v[16:31]
    buffer_load_dwordx4 v202, s[40:43], s75 offen lds
    ds_read_b64_tr_b16 v[148:149], v192 offset:45056
    ds_read_b64_tr_b16 v[150:151], v192 offset:45568
    s_waitcnt lgkmcnt(5)
    v_mfma_f32_32x32x16_bf16 v[32:47], v[160:163], a[68:71], v[32:47]
    ds_read_b64_tr_b16 v[152:153], v193 offset:45056
    ds_read_b64_tr_b16 v[154:155], v193 offset:45568
    v_cndmask_b32 v228, v114, v113, vcc
    s_mov_b32 s3, 0
fused_kernel_non_chk:
    v_readfirstlane_b32 s4, v106
    v_readfirstlane_b32 s5, v107
    s_nop 0
    s_cmp_eq_u32 s4, 0
    s_cbranch_scc0 fused_kernel_non_ok
fused_kernel_non_retry:
    s_add_u32 s3, s3, 1
    s_cmp_gt_u32 s3, 0x40000
    s_cbranch_scc1 fused_kernel_non_ok
    s_sleep 4
    global_load_dwordx2 v[106:107], v105, s[28:29] sc1
    s_waitcnt vmcnt(0)
    s_branch fused_kernel_non_chk
fused_kernel_non_ok:
    v_mfma_f32_32x32x16_bf16 v[48:63], v[160:163], a[196:199], v[48:63]
    buffer_load_dwordx4 v203, s[40:43], s75 offen offset:1024 lds
    s_lshl_b32 s20, s49, 5
    s_add_u32 s20, s20, s48
    v_mfma_f32_32x32x16_bf16 v[64:79], v[164:167], a[68:71], v[64:79]
    s_lshl_b32 s20, s20, 7
    s_lshl_b32 s21, s64, 3
    s_add_u32 s20, s20, s21
    s_add_u32 s20, s20, 14680064
    v_mov_b32 v100, s4
    v_mov_b32 v101, s5
    v_lshl_add_u32 v102, v209, 24, s20
    buffer_store_dwordx2 v[100:101], v102, s[44:47], 0 offen sc1
    v_mfma_f32_32x32x16_bf16 v[80:95], v[164:167], a[196:199], v[80:95]
    buffer_load_dwordx4 v204, s[40:43], s75 offen offset:2048 lds
    v_lshlrev_b32 v112, 16, v140
    s_waitcnt lgkmcnt(4)
    v_mfma_f32_32x32x16_bf16 v[0:15], a[72:75], v[144:147], v[0:15]
    ds_read_b128 a[76:79], v171 offset:40960
    ds_read_b128 v[156:159], v187 offset:40960
    ds_read_b128 a[204:207], v175 offset:40960
    v_and_b32 v113, 0xffff0000, v140
    v_lshlrev_b32 v114, 16, v141
    v_mfma_f32_32x32x16_bf16 v[16:31], a[200:203], v[144:147], v[16:31]
    buffer_load_dwordx4 v205, s[40:43], s75 offen offset:3072 lds
    s_add_u32 m0, s60, 139264
    ds_read_b64_tr_b16 v[160:161], v192 offset:47104
    ds_read_b64_tr_b16 v[162:163], v192 offset:47616
    s_waitcnt lgkmcnt(5)
    v_mfma_f32_32x32x16_bf16 v[32:47], v[148:151], a[72:75], v[32:47]
    ds_read_b64_tr_b16 v[164:165], v193 offset:47104
    ds_read_b64_tr_b16 v[166:167], v193 offset:47616
    v_and_b32 v115, 0xffff0000, v141
    v_lshlrev_b32 v116, 16, v142
    v_and_b32 v117, 0xffff0000, v142
    v_mfma_f32_32x32x16_bf16 v[48:63], v[148:151], a[200:203], v[48:63]
    buffer_load_dwordx4 v242, s[40:43], s62 offen offset:1024 lds
    v_lshlrev_b32 v118, 16, v143
    v_and_b32 v119, 0xffff0000, v143
    v_mfma_f32_32x32x16_bf16 v[64:79], v[152:155], a[72:75], v[64:79]
    v_lshlrev_b32 v120, 16, v132
    v_and_b32 v121, 0xffff0000, v132
    v_mul_f32 v120, v120, v112
    v_mul_f32 v121, v121, v113
    v_cvt_pk_bf16_f32 v122, v120, v121
    v_mfma_f32_32x32x16_bf16 v[80:95], v[152:155], a[200:203], v[80:95]
    buffer_load_dwordx4 v243, s[40:43], s62 offen offset:2048 lds
    v_lshlrev_b32 v120, 16, v122
    s_waitcnt lgkmcnt(4)
    v_mfma_f32_32x32x16_bf16 v[0:15], a[76:79], v[156:159], v[0:15]
    s_waitcnt vmcnt(15)
    s_waitcnt lgkmcnt(0)
    s_barrier
    s_add_u32 s74, s74, 128
    s_and_b32 s74, s74, 1023
    s_mul_i32 s75, s74, 1792
    s_add_u32 m0, s60, 40960
    ds_read_b128 a[80:83], v176 offset:0
    ds_read_b128 v[144:147], v188 offset:0
    ds_read_b128 a[208:211], v180 offset:0
    v_mfma_f32_32x32x16_bf16 v[16:31], a[204:207], v[156:159], v[16:31]
    buffer_load_dwordx4 v196, s[32:35], s74 offen lds
    ds_read_b64_tr_b16 v[148:149], v194 offset:0
    ds_read_b64_tr_b16 v[150:151], v194 offset:512
    v_mfma_f32_32x32x16_bf16 v[32:47], v[160:163], a[76:79], v[32:47]
    ds_read_b64_tr_b16 v[152:153], v195 offset:0
    ds_read_b64_tr_b16 v[154:155], v195 offset:512
    v_and_b32 v121, 0xffff0000, v122
    v_add_f32 v124, v120, v121
    v_lshlrev_b32 v120, 16, v133
    v_mfma_f32_32x32x16_bf16 v[48:63], v[160:163], a[204:207], v[48:63]
    buffer_load_dwordx4 v197, s[32:35], s74 offen offset:1024 lds
    v_and_b32 v121, 0xffff0000, v133
    v_mul_f32 v120, v120, v114
    v_mfma_f32_32x32x16_bf16 v[64:79], v[164:167], a[76:79], v[64:79]
    v_mul_f32 v121, v121, v115
    v_cvt_pk_bf16_f32 v122, v120, v121
    v_lshlrev_b32 v120, 16, v122
    v_and_b32 v121, 0xffff0000, v122
    v_add_f32 v124, v124, v120
    v_mfma_f32_32x32x16_bf16 v[80:95], v[164:167], a[204:207], v[80:95]
    buffer_load_dwordx4 v198, s[32:35], s74 offen offset:2048 lds
    v_add_f32 v124, v124, v121
    s_waitcnt lgkmcnt(4)
    v_mfma_f32_32x32x16_bf16 v[0:15], a[80:83], v[144:147], v[0:15]
    ds_read_b128 a[84:87], v177 offset:0
    ds_read_b128 v[156:159], v189 offset:0
    ds_read_b128 a[212:215], v181 offset:0
    v_lshlrev_b32 v120, 16, v134
    v_and_b32 v121, 0xffff0000, v134
    v_mfma_f32_32x32x16_bf16 v[16:31], a[208:211], v[144:147], v[16:31]
    buffer_load_dwordx4 v199, s[32:35], s74 offen offset:3072 lds
    s_add_u32 m0, s61, 40960
    ds_read_b64_tr_b16 v[160:161], v194 offset:2048
    ds_read_b64_tr_b16 v[162:163], v194 offset:2560
    s_waitcnt lgkmcnt(5)
    v_mfma_f32_32x32x16_bf16 v[32:47], v[148:151], a[80:83], v[32:47]
    ds_read_b64_tr_b16 v[164:165], v195 offset:2048
    ds_read_b64_tr_b16 v[166:167], v195 offset:2560
    v_mul_f32 v120, v120, v116
    v_mul_f32 v121, v121, v117
    v_cvt_pk_bf16_f32 v122, v120, v121
    v_mfma_f32_32x32x16_bf16 v[48:63], v[148:151], a[208:211], v[48:63]
    buffer_load_dwordx4 v200, s[36:39], s74 offen lds
    v_lshlrev_b32 v120, 16, v122
    v_and_b32 v121, 0xffff0000, v122
    v_mfma_f32_32x32x16_bf16 v[64:79], v[152:155], a[80:83], v[64:79]
    v_add_f32 v124, v124, v120
    v_add_f32 v124, v124, v121
    v_lshlrev_b32 v120, 16, v135
    v_and_b32 v121, 0xffff0000, v135
    v_mul_f32 v120, v120, v118
    v_mfma_f32_32x32x16_bf16 v[80:95], v[152:155], a[208:211], v[80:95]
    buffer_load_dwordx4 v201, s[36:39], s74 offen offset:1024 lds
    s_add_u32 m0, s60, 65536
    s_waitcnt lgkmcnt(4)
    v_mfma_f32_32x32x16_bf16 v[0:15], a[84:87], v[156:159], v[0:15]
    ds_read_b128 a[88:91], v178 offset:0
    ds_read_b128 v[144:147], v190 offset:0
    ds_read_b128 a[216:219], v182 offset:0
    v_mul_f32 v121, v121, v119
    v_cvt_pk_bf16_f32 v122, v120, v121
    v_mfma_f32_32x32x16_bf16 v[16:31], a[212:215], v[156:159], v[16:31]
    buffer_load_dwordx4 v202, s[40:43], s75 offen lds
    ds_read_b64_tr_b16 v[148:149], v194 offset:4096
    ds_read_b64_tr_b16 v[150:151], v194 offset:4608
    s_waitcnt lgkmcnt(5)
    v_mfma_f32_32x32x16_bf16 v[32:47], v[160:163], a[84:87], v[32:47]
    ds_read_b64_tr_b16 v[152:153], v195 offset:4096
    ds_read_b64_tr_b16 v[154:155], v195 offset:4608
    v_lshlrev_b32 v120, 16, v122
    v_and_b32 v121, 0xffff0000, v122
    v_add_f32 v124, v124, v120
    v_mfma_f32_32x32x16_bf16 v[48:63], v[160:163], a[212:215], v[48:63]
    buffer_load_dwordx4 v203, s[40:43], s75 offen offset:1024 lds
    v_add_f32 v124, v124, v121
    v_lshlrev_b32 v120, 16, v136
    v_mfma_f32_32x32x16_bf16 v[64:79], v[164:167], a[84:87], v[64:79]
    v_and_b32 v121, 0xffff0000, v136
    v_mul_f32 v120, v120, v112
    v_mul_f32 v121, v121, v113
    v_cvt_pk_bf16_f32 v122, v120, v121
    v_lshlrev_b32 v120, 16, v122
    v_mfma_f32_32x32x16_bf16 v[80:95], v[164:167], a[212:215], v[80:95]
    buffer_load_dwordx4 v204, s[40:43], s75 offen offset:2048 lds
    v_and_b32 v121, 0xffff0000, v122
    s_waitcnt lgkmcnt(4)
    v_mfma_f32_32x32x16_bf16 v[0:15], a[88:91], v[144:147], v[0:15]
    ds_read_b128 a[92:95], v179 offset:0
    ds_read_b128 v[156:159], v191 offset:0
    ds_read_b128 a[220:223], v183 offset:0
    v_add_f32 v125, v120, v121
    v_lshlrev_b32 v120, 16, v137
    v_mfma_f32_32x32x16_bf16 v[16:31], a[216:219], v[144:147], v[16:31]
    buffer_load_dwordx4 v205, s[40:43], s75 offen offset:3072 lds
    s_add_u32 m0, s60, 139264
    ds_read_b64_tr_b16 v[160:161], v194 offset:6144
    ds_read_b64_tr_b16 v[162:163], v194 offset:6656
    s_waitcnt lgkmcnt(5)
    v_mfma_f32_32x32x16_bf16 v[32:47], v[148:151], a[88:91], v[32:47]
    ds_read_b64_tr_b16 v[164:165], v195 offset:6144
    ds_read_b64_tr_b16 v[166:167], v195 offset:6656
    v_and_b32 v121, 0xffff0000, v137
    v_mul_f32 v120, v120, v114
    v_mul_f32 v121, v121, v115
    v_mfma_f32_32x32x16_bf16 v[48:63], v[148:151], a[216:219], v[48:63]
    buffer_load_dwordx4 v244, s[40:43], s62 offen offset:3072 lds
    v_cvt_pk_bf16_f32 v122, v120, v121
    v_lshlrev_b32 v120, 16, v122
    v_mfma_f32_32x32x16_bf16 v[64:79], v[152:155], a[88:91], v[64:79]
    v_and_b32 v121, 0xffff0000, v122
    v_add_f32 v125, v125, v120
    v_add_f32 v125, v125, v121
    v_lshlrev_b32 v120, 16, v138
    v_and_b32 v121, 0xffff0000, v138
    v_mfma_f32_32x32x16_bf16 v[80:95], v[152:155], a[216:219], v[80:95]
    v_mul_f32 v120, v120, v116
    v_mul_f32 v121, v121, v117
    v_cvt_pk_bf16_f32 v122, v120, v121
    s_waitcnt lgkmcnt(4)
    v_mfma_f32_32x32x16_bf16 v[0:15], a[92:95], v[156:159], v[0:15]
    s_waitcnt vmcnt(13)
    s_waitcnt lgkmcnt(0)
    s_barrier
    s_add_u32 s17, s69, 2
    s_and_b32 s17, s17, 7
    s_mul_i32 s62, s17, 229376
    s_add_u32 m0, s60, 81920
    ds_read_b128 a[96:99], v168 offset:0
    ds_read_b128 v[144:147], v184 offset:0
    ds_read_b128 a[224:227], v172 offset:0
    v_mfma_f32_32x32x16_bf16 v[16:31], a[220:223], v[156:159], v[16:31]
    buffer_load_dwordx4 v241, s[40:43], s62 offen lds
    ds_read_b64_tr_b16 v[148:149], v192 offset:0
    ds_read_b64_tr_b16 v[150:151], v192 offset:512
    v_mfma_f32_32x32x16_bf16 v[32:47], v[160:163], a[92:95], v[32:47]
    buffer_load_dwordx4 v242, s[40:43], s62 offen offset:1024 lds
    ds_read_b64_tr_b16 v[152:153], v193 offset:0
    ds_read_b64_tr_b16 v[154:155], v193 offset:512
    v_lshlrev_b32 v120, 16, v122
    v_mfma_f32_32x32x16_bf16 v[48:63], v[160:163], a[220:223], v[48:63]
    buffer_load_dwordx4 v243, s[40:43], s62 offen offset:2048 lds
    v_and_b32 v121, 0xffff0000, v122
    v_add_f32 v125, v125, v120
    v_mfma_f32_32x32x16_bf16 v[64:79], v[164:167], a[92:95], v[64:79]
    v_add_f32 v125, v125, v121
    v_lshlrev_b32 v120, 16, v139
    v_and_b32 v121, 0xffff0000, v139
    v_mul_f32 v120, v120, v118
    v_mul_f32 v121, v121, v119
    v_mfma_f32_32x32x16_bf16 v[80:95], v[164:167], a[220:223], v[80:95]
    buffer_load_dwordx4 v244, s[40:43], s62 offen offset:3072 lds
    s_add_u32 s17, s69, 3
    s_and_b32 s17, s17, 7
    s_mul_i32 s62, s17, 229376
    s_add_u32 m0, s60, 98304
    s_waitcnt lgkmcnt(4)
    v_mfma_f32_32x32x16_bf16 v[0:15], a[96:99], v[144:147], v[0:15]
    ds_read_b128 a[100:103], v169 offset:0
    ds_read_b128 v[156:159], v185 offset:0
    ds_read_b128 a[228:231], v173 offset:0
    v_cvt_pk_bf16_f32 v122, v120, v121
    v_lshlrev_b32 v120, 16, v122
    v_mfma_f32_32x32x16_bf16 v[16:31], a[224:227], v[144:147], v[16:31]
    buffer_load_dwordx4 v241, s[40:43], s62 offen lds
    ds_read_b64_tr_b16 v[160:161], v192 offset:2048
    ds_read_b64_tr_b16 v[162:163], v192 offset:2560
    s_waitcnt lgkmcnt(5)
    v_mfma_f32_32x32x16_bf16 v[32:47], v[148:151], a[96:99], v[32:47]
    ds_read_b64_tr_b16 v[164:165], v193 offset:2048
    ds_read_b64_tr_b16 v[166:167], v193 offset:2560
    v_and_b32 v121, 0xffff0000, v122
    v_add_f32 v125, v125, v120
    v_add_f32 v125, v125, v121
    v_mfma_f32_32x32x16_bf16 v[48:63], v[148:151], a[224:227], v[48:63]
    buffer_load_dwordx4 v242, s[40:43], s62 offen offset:1024 lds
    v_add_f32_dpp v124, v124, v124 row_shr:1 row_mask:0xf bank_mask:0xf
    v_add_f32_dpp v125, v125, v125 row_shr:1 row_mask:0xf bank_mask:0xf
    v_mfma_f32_32x32x16_bf16 v[64:79], v[152:155], a[96:99], v[64:79]
    v_add_f32_dpp v124, v124, v124 row_shr:2 row_mask:0xf bank_mask:0xf
    v_add_f32_dpp v125, v125, v125 row_shr:2 row_mask:0xf bank_mask:0xf
    s_nop 0
    v_add_f32_dpp v124, v124, v124 row_shr:4 row_mask:0xf bank_mask:0xf
    v_add_f32_dpp v125, v125, v125 row_shr:4 row_mask:0xf bank_mask:0xf
    v_mfma_f32_32x32x16_bf16 v[80:95], v[152:155], a[224:227], v[80:95]
    buffer_load_dwordx4 v243, s[40:43], s62 offen offset:2048 lds
    v_add_f32_dpp v124, v124, v124 row_shr:8 row_mask:0xf bank_mask:0xf
    s_waitcnt lgkmcnt(4)
    v_mfma_f32_32x32x16_bf16 v[0:15], a[100:103], v[156:159], v[0:15]
    ds_read_b128 a[104:107], v170 offset:0
    ds_read_b128 v[144:147], v186 offset:0
    ds_read_b128 a[232:235], v174 offset:0
    v_add_f32_dpp v125, v125, v125 row_shr:8 row_mask:0xf bank_mask:0xf
    v_add_f32_dpp v124, v124, v124 row_bcast:15 row_mask:0xa bank_mask:0xf
    v_mfma_f32_32x32x16_bf16 v[16:31], a[228:231], v[156:159], v[16:31]
    buffer_load_dwordx4 v244, s[40:43], s62 offen offset:3072 lds
    ds_read_b64_tr_b16 v[148:149], v192 offset:4096
    ds_read_b64_tr_b16 v[150:151], v192 offset:4608
    s_waitcnt lgkmcnt(5)
    v_mfma_f32_32x32x16_bf16 v[32:47], v[160:163], a[100:103], v[32:47]
    ds_read_b64_tr_b16 v[152:153], v193 offset:4096
    ds_read_b64_tr_b16 v[154:155], v193 offset:4608
    v_add_f32_dpp v125, v125, v125 row_bcast:15 row_mask:0xa bank_mask:0xf
    v_add_f32_dpp v124, v124, v124 row_bcast:31 row_mask:0xc bank_mask:0xf
    s_nop 0
    v_add_f32_dpp v125, v125, v125 row_bcast:31 row_mask:0xc bank_mask:0xf
    v_mfma_f32_32x32x16_bf16 v[48:63], v[160:163], a[228:231], v[48:63]
    v_cvt_pk_bf16_f32 v120, v124, v125
    v_lshlrev_b32 v124, 16, v120
    v_and_b32 v125, 0xffff0000, v120
    v_mul_f32 v124, 0xbfb8aa3b, v124
    v_mfma_f32_32x32x16_bf16 v[64:79], v[164:167], a[100:103], v[64:79]
    v_mul_f32 v125, 0xbfb8aa3b, v125
    v_exp_f32 v124, v124
    v_exp_f32 v125, v125
    v_mfma_f32_32x32x16_bf16 v[80:95], v[164:167], a[228:231], v[80:95]
    v_add_f32 v124, 1.0, v124
    v_add_f32 v125, 1.0, v125
    v_rcp_f32 v124, v124
    s_waitcnt lgkmcnt(4)
    v_mfma_f32_32x32x16_bf16 v[0:15], a[104:107], v[144:147], v[0:15]
    ds_read_b128 a[108:111], v171 offset:0
    ds_read_b128 v[156:159], v187 offset:0
    ds_read_b128 a[236:239], v175 offset:0
    v_rcp_f32 v125, v125
    v_mfma_f32_32x32x16_bf16 v[16:31], a[232:235], v[144:147], v[16:31]
    ds_read_b64_tr_b16 v[160:161], v192 offset:6144
    ds_read_b64_tr_b16 v[162:163], v192 offset:6656
    v_cvt_pk_bf16_f32 v120, v124, v125
    v_lshlrev_b32 v124, 16, v120
    s_waitcnt lgkmcnt(5)
    v_mfma_f32_32x32x16_bf16 v[32:47], v[148:151], a[104:107], v[32:47]
    ds_read_b64_tr_b16 v[164:165], v193 offset:6144
    ds_read_b64_tr_b16 v[166:167], v193 offset:6656
    v_and_b32 v125, 0xffff0000, v120
    v_sub_f32 v120, 1.0, v124
    v_sub_f32 v121, 1.0, v125
    v_mfma_f32_32x32x16_bf16 v[48:63], v[148:151], a[232:235], v[48:63]
    v_cvt_pk_bf16_f32 v122, v124, v120
    v_cvt_pk_bf16_f32 v123, v125, v121
    s_lshl_b32 s20, s14, 2
    s_add_u32 s20, s20, 14417920
    v_mfma_f32_32x32x16_bf16 v[64:79], v[152:155], a[104:107], v[64:79]
    v_mov_b32 v120, s20
    v_mov_b32 v121, 0x1000000
    v_cmp_eq_u32 vcc, 63, v209
    s_nop 1
    v_cndmask_b32 v120, v121, v120, vcc
    v_mfma_f32_32x32x16_bf16 v[80:95], v[152:155], a[232:235], v[80:95]
    buffer_store_dwordx2 v[122:123], v120, s[44:47], 0 offen sc1
    v_and_b32 v104, 3, v231
    s_waitcnt lgkmcnt(4)
    v_mfma_f32_32x32x16_bf16 v[0:15], a[108:111], v[156:159], v[0:15]
    s_waitcnt vmcnt(10)
    s_waitcnt lgkmcnt(0)
    s_barrier
    s_add_u32 s17, s69, 4
    s_and_b32 s17, s17, 7
    s_mul_i32 s62, s17, 229376
    s_add_u32 m0, s60, 0
    ds_read_b128 a[112:115], v168 offset:40960
    ds_read_b128 v[144:147], v184 offset:40960
    ds_read_b128 a[240:243], v172 offset:40960
    v_mfma_f32_32x32x16_bf16 v[16:31], a[236:239], v[156:159], v[16:31]
    buffer_load_dwordx4 v241, s[40:43], s62 offen lds
    ds_read_b64_tr_b16 v[148:149], v192 offset:40960
    ds_read_b64_tr_b16 v[150:151], v192 offset:41472
    v_mfma_f32_32x32x16_bf16 v[32:47], v[160:163], a[108:111], v[32:47]
    buffer_load_dwordx4 v242, s[40:43], s62 offen offset:1024 lds
    ds_read_b64_tr_b16 v[152:153], v193 offset:40960
    ds_read_b64_tr_b16 v[154:155], v193 offset:41472
    v_lshlrev_b32 v104, 1, v104
    v_mfma_f32_32x32x16_bf16 v[48:63], v[160:163], a[236:239], v[48:63]
    buffer_load_dwordx4 v243, s[40:43], s62 offen offset:2048 lds
    v_and_b32 v105, 7, v209
    v_xor_b32 v104, v104, v105
    v_mfma_f32_32x32x16_bf16 v[64:79], v[164:167], a[108:111], v[64:79]
    buffer_load_dwordx4 v244, s[40:43], s62 offen offset:3072 lds
    s_add_u32 s17, s69, 5
    s_and_b32 s17, s17, 7
    s_mul_i32 s62, s17, 229376
    s_add_u32 m0, s60, 16384
    v_mfma_f32_32x32x16_bf16 v[80:95], v[164:167], a[236:239], v[80:95]
    v_lshlrev_b32 v104, 4, v104
    v_and_b32 v105, 15, v209
    v_lshl_add_u32 v104, v105, 7, v104
    s_waitcnt lgkmcnt(4)
    v_mfma_f32_32x32x16_bf16 v[0:15], a[112:115], v[144:147], v[0:15]
    buffer_load_dwordx4 v241, s[40:43], s62 offen lds
    ds_read_b128 a[116:119], v169 offset:40960
    ds_read_b128 v[156:159], v185 offset:40960
    ds_read_b128 a[244:247], v173 offset:40960
    v_mfma_f32_32x32x16_bf16 v[16:31], a[240:243], v[144:147], v[16:31]
    ds_read_b64_tr_b16 v[160:161], v192 offset:43008
    ds_read_b64_tr_b16 v[162:163], v192 offset:43520
    s_lshl_b32 s20, s64, 12
    s_add_u32 s20, s20, 122880
    s_waitcnt lgkmcnt(5)
    v_mfma_f32_32x32x16_bf16 v[32:47], v[148:151], a[112:115], v[32:47]
    buffer_load_dwordx4 v242, s[40:43], s62 offen offset:1024 lds
    ds_read_b64_tr_b16 v[164:165], v193 offset:43008
    ds_read_b64_tr_b16 v[166:167], v193 offset:43520
    v_add_u32 v233, s20, v104
    v_mfma_f32_32x32x16_bf16 v[48:63], v[148:151], a[240:243], v[48:63]
    v_xor_b32 v234, 16, v233
    v_bfe_u32 v104, v209, 4, 1
    v_lshlrev_b32 v104, 1, v104
    v_bfe_u32 v105, v209, 1, 1
    v_mfma_f32_32x32x16_bf16 v[64:79], v[152:155], a[112:115], v[64:79]
    buffer_load_dwordx4 v243, s[40:43], s62 offen offset:2048 lds
    v_add_u32 v104, v104, v105
    v_bfe_u32 v105, v209, 2, 2
    v_xor_b32 v104, v104, v105
    v_mfma_f32_32x32x16_bf16 v[80:95], v[152:155], a[240:243], v[80:95]
    v_lshlrev_b32 v104, 4, v104
    v_lshl_add_u32 v104, v105, 7, v104
    v_lshrrev_b32 v105, 5, v209
    s_waitcnt lgkmcnt(4)
    v_mfma_f32_32x32x16_bf16 v[0:15], a[116:119], v[156:159], v[0:15]
    buffer_load_dwordx4 v244, s[40:43], s62 offen offset:3072 lds
    ds_read_b128 a[120:123], v170 offset:40960
    ds_read_b128 v[144:147], v186 offset:40960
    ds_read_b128 a[248:251], v174 offset:40960
    v_mfma_f32_32x32x16_bf16 v[16:31], a[244:247], v[156:159], v[16:31]
    ds_read_b64_tr_b16 v[148:149], v192 offset:45056
    ds_read_b64_tr_b16 v[150:151], v192 offset:45568
    v_lshl_add_u32 v104, v105, 10, v104
    v_and_b32 v105, 1, v209
    s_waitcnt lgkmcnt(5)
    v_mfma_f32_32x32x16_bf16 v[32:47], v[160:163], a[116:119], v[32:47]
    ds_read_b64_tr_b16 v[152:153], v193 offset:45056
    ds_read_b64_tr_b16 v[154:155], v193 offset:45568
    v_lshl_add_u32 v104, v105, 3, v104
    v_add_u32 v235, s20, v104
    v_xor_b32 v236, 64, v235
    v_mfma_f32_32x32x16_bf16 v[48:63], v[160:163], a[244:247], v[48:63]
    s_lshl_b32 s16, s68, 1
    s_add_u32 s16, s16, s66
    s_lshl_b32 s16, s16, 12
    s_add_u32 s16, s16, s15
    v_mfma_f32_32x32x16_bf16 v[64:79], v[164:167], a[116:119], v[64:79]
    v_lshrrev_b32 v104, 1, v209
    v_and_b32 v105, 1, v209
    v_lshlrev_b32 v105, 4, v105
    v_lshl_add_u32 v104, v104, 7, v105
    s_lshl_b32 s20, s49, 12
    v_mfma_f32_32x32x16_bf16 v[80:95], v[164:167], a[244:247], v[80:95]
    s_add_u32 s20, s20, 14680064
    v_add_u32 v232, s20, v104
    s_waitcnt lgkmcnt(4)
    v_mfma_f32_32x32x16_bf16 v[0:15], a[120:123], v[144:147], v[0:15]
    ds_read_b128 a[124:127], v171 offset:40960
    ds_read_b128 v[156:159], v187 offset:40960
    ds_read_b128 a[252:255], v175 offset:40960
    v_mfma_f32_32x32x16_bf16 v[16:31], a[248:251], v[144:147], v[16:31]
    ds_read_b64_tr_b16 v[160:161], v192 offset:47104
    ds_read_b64_tr_b16 v[162:163], v192 offset:47616
    s_waitcnt lgkmcnt(5)
    v_mfma_f32_32x32x16_bf16 v[32:47], v[148:151], a[120:123], v[32:47]
    ds_read_b64_tr_b16 v[164:165], v193 offset:47104
    ds_read_b64_tr_b16 v[166:167], v193 offset:47616
    v_mfma_f32_32x32x16_bf16 v[48:63], v[148:151], a[248:251], v[48:63]
    v_mfma_f32_32x32x16_bf16 v[64:79], v[152:155], a[120:123], v[64:79]
    v_mfma_f32_32x32x16_bf16 v[80:95], v[152:155], a[248:251], v[80:95]
    s_waitcnt lgkmcnt(4)
    v_mfma_f32_32x32x16_bf16 v[0:15], a[124:127], v[156:159], v[0:15]
    s_waitcnt vmcnt(17)
    s_waitcnt lgkmcnt(0)
    s_barrier
    s_add_u32 s17, s69, 6
    s_and_b32 s17, s17, 7
    s_mul_i32 s62, s17, 229376
    s_add_u32 m0, s60, 40960
    ds_read_b64_tr_b16 v[144:145], v239 offset:40960
    ds_read_b64_tr_b16 v[146:147], v239 offset:41472
    v_mfma_f32_32x32x16_bf16 v[16:31], a[252:255], v[156:159], v[16:31]
    buffer_load_dwordx4 v241, s[40:43], s62 offen lds
    ds_read_b64_tr_b16 v[148:149], v240 offset:40960
    ds_read_b64_tr_b16 v[150:151], v240 offset:41472
    v_mfma_f32_32x32x16_bf16 v[32:47], v[160:163], a[124:127], v[32:47]
    buffer_load_dwordx4 v242, s[40:43], s62 offen offset:1024 lds
    ds_read_b64_tr_b16 v[152:153], v239 offset:43008
    ds_read_b64_tr_b16 v[154:155], v239 offset:43520
    v_mfma_f32_32x32x16_bf16 v[48:63], v[160:163], a[252:255], v[48:63]
    buffer_load_dwordx4 v243, s[40:43], s62 offen offset:2048 lds
    ds_read_b64_tr_b16 v[156:157], v240 offset:43008
    ds_read_b64_tr_b16 v[158:159], v240 offset:43520
    v_mfma_f32_32x32x16_bf16 v[64:79], v[164:167], a[124:127], v[64:79]
    buffer_load_dwordx4 v244, s[40:43], s62 offen offset:3072 lds
    s_add_u32 s17, s69, 7
    s_and_b32 s17, s17, 7
    s_mul_i32 s62, s17, 229376
    s_add_u32 m0, s60, 57344
    v_mfma_f32_32x32x16_bf16 v[80:95], v[164:167], a[252:255], v[80:95]
    s_waitcnt lgkmcnt(4)
    v_mfma_f32_32x32x16_bf16 v[96:111], v[144:147], a[0:3], 0
    buffer_load_dwordx4 v241, s[40:43], s62 offen lds
    ds_read_b64_tr_b16 v[160:161], v239 offset:45056
    ds_read_b64_tr_b16 v[162:163], v239 offset:45568
    v_permlane16_swap_b32 v0, v16
    v_permlane16_swap_b32 v1, v17
    v_mfma_f32_32x32x16_bf16 v[112:127], v[144:147], a[128:131], 0
    ds_read_b64_tr_b16 v[164:165], v240 offset:45056
    ds_read_b64_tr_b16 v[166:167], v240 offset:45568
    v_mul_f32 v200, 0xbfb8aa3b, v32
    v_permlane16_swap_b32 v2, v18
    v_permlane16_swap_b32 v3, v19
    v_mul_f32 v201, 0xbfb8aa3b, v33
    v_mfma_f32_32x32x16_bf16 v[128:143], v[148:151], a[0:3], 0
    buffer_load_dwordx4 v242, s[40:43], s62 offen offset:1024 lds
    v_permlane16_swap_b32 v4, v20
    v_permlane16_swap_b32 v5, v21
    v_mul_f32 v202, 0xbfb8aa3b, v34
    v_permlane16_swap_b32 v6, v22
    v_mfma_f32_32x32x16_bf16 v[168:183], v[148:151], a[128:131], 0
    v_permlane16_swap_b32 v7, v23
    v_mul_f32 v203, 0xbfb8aa3b, v35
    v_permlane16_swap_b32 v8, v24
    v_permlane16_swap_b32 v9, v25
    v_exp_f32 v200, v200
    s_waitcnt lgkmcnt(4)
    v_mfma_f32_32x32x16_bf16 v[96:111], v[152:155], a[4:7], v[96:111]
    buffer_load_dwordx4 v243, s[40:43], s62 offen offset:2048 lds
    ds_read_b64_tr_b16 v[144:145], v239 offset:47104
    ds_read_b64_tr_b16 v[146:147], v239 offset:47616
    v_permlane16_swap_b32 v10, v26
    v_permlane16_swap_b32 v11, v27
    v_mfma_f32_32x32x16_bf16 v[112:127], v[152:155], a[132:135], v[112:127]
    ds_read_b64_tr_b16 v[148:149], v240 offset:47104
    ds_read_b64_tr_b16 v[150:151], v240 offset:47616
    v_exp_f32 v201, v201
    v_permlane16_swap_b32 v12, v28
    v_permlane16_swap_b32 v13, v29
    v_mfma_f32_32x32x16_bf16 v[128:143], v[156:159], a[4:7], v[128:143]
    buffer_load_dwordx4 v244, s[40:43], s62 offen offset:3072 lds
    v_exp_f32 v202, v202
    v_permlane16_swap_b32 v14, v30
    v_permlane16_swap_b32 v15, v31
    v_mfma_f32_32x32x16_bf16 v[168:183], v[156:159], a[132:135], v[168:183]
    v_exp_f32 v203, v203
    v_fma_f32 v248, v210, v0, v1
    v_fma_f32 v249, v210, v16, v17
    v_mul_f32 v40, v32, v40
    v_fma_f32 v248, -v211, v16, v248
    s_waitcnt lgkmcnt(4)
    v_mfma_f32_32x32x16_bf16 v[96:111], v[160:163], a[8:11], v[96:111]
    ds_read_b64_tr_b16 v[152:153], v239 offset:57344
    ds_read_b64_tr_b16 v[154:155], v239 offset:57856
    v_fma_f32 v249, v211, v0, v249
    v_mul_f32 v41, v33, v41
    v_fma_f32 v246, v210, v248, v2
    v_fma_f32 v247, v210, v249, v18
    v_mfma_f32_32x32x16_bf16 v[112:127], v[160:163], a[136:139], v[112:127]
    ds_read_b64_tr_b16 v[156:157], v240 offset:57344
    ds_read_b64_tr_b16 v[158:159], v240 offset:57856
    v_mul_f32 v42, v34, v42
    v_fma_f32 v246, -v211, v249, v246
    v_fma_f32 v247, v211, v248, v247
    v_mul_f32 v43, v35, v43
    v_mfma_f32_32x32x16_bf16 v[128:143], v[164:167], a[8:11], v[128:143]
    v_fma_f32 v248, v210, v246, v3
    v_fma_f32 v249, v210, v247, v19
    v_add_f32 v200, 1.0, v200
    v_fma_f32 v248, -v211, v247, v248
    v_fma_f32 v249, v211, v246, v249
    v_add_f32 v201, 1.0, v201
    v_mfma_f32_32x32x16_bf16 v[168:183], v[164:167], a[136:139], v[168:183]
    v_fma_f32 v246, v210, v248, v4
    v_fma_f32 v247, v210, v249, v20
    v_add_f32 v202, 1.0, v202
    v_fma_f32 v246, -v211, v249, v246
    v_fma_f32 v247, v211, v248, v247
    v_add_f32 v203, 1.0, v203
    s_waitcnt lgkmcnt(4)
    v_mfma_f32_32x32x16_bf16 v[96:111], v[144:147], a[12:15], v[96:111]
    ds_read_b64_tr_b16 v[160:161], v239 offset:59392
    ds_read_b64_tr_b16 v[162:163], v239 offset:59904
    v_fma_f32 v248, v210, v246, v5
    v_fma_f32 v249, v210, v247, v21
    v_rcp_f32 v200, v200
    v_mfma_f32_32x32x16_bf16 v[112:127], v[144:147], a[140:143], v[112:127]
    ds_read_b64_tr_b16 v[164:165], v240 offset:59392
    ds_read_b64_tr_b16 v[166:167], v240 offset:59904
    v_fma_f32 v248, -v211, v247, v248
    v_fma_f32 v249, v211, v246, v249
    v_rcp_f32 v201, v201
    v_mfma_f32_32x32x16_bf16 v[128:143], v[148:151], a[12:15], v[128:143]
    v_fma_f32 v246, v210, v248, v6
    v_fma_f32 v247, v210, v249, v22
    v_rcp_f32 v202, v202
    v_fma_f32 v246, -v211, v249, v246
    v_fma_f32 v247, v211, v248, v247
    v_mfma_f32_32x32x16_bf16 v[168:183], v[148:151], a[140:143], v[168:183]
    v_rcp_f32 v203, v203
    v_fma_f32 v248, v210, v246, v7
    v_fma_f32 v249, v210, v247, v23
    v_mul_f32 v40, v40, v200
    v_fma_f32 v248, -v211, v247, v248
    s_waitcnt lgkmcnt(4)
    v_mfma_f32_32x32x16_bf16 v[96:111], v[152:155], a[16:19], v[96:111]
    v_fma_f32 v249, v211, v246, v249
    v_mul_f32 v41, v41, v201
    v_fma_f32 v246, v210, v248, v8
    v_fma_f32 v247, v210, v249, v24
    v_mul_f32 v42, v42, v202
    v_fma_f32 v246, -v211, v249, v246
    v_fma_f32 v247, v211, v248, v247
    v_mul_f32 v43, v43, v203
    v_fma_f32 v248, v210, v246, v9
    v_fma_f32 v249, v210, v247, v25
    v_cvt_pk_bf16_f32 v32, v40, v41
    v_fma_f32 v248, -v211, v247, v248
    v_fma_f32 v249, v211, v246, v249
    v_cvt_pk_bf16_f32 v33, v42, v43
    v_fma_f32 v246, v210, v248, v10
    v_fma_f32 v247, v210, v249, v26
    v_mul_f32 v200, 0xbfb8aa3b, v36
    v_fma_f32 v246, -v211, v249, v246
    v_fma_f32 v247, v211, v248, v247
    v_mul_f32 v201, 0xbfb8aa3b, v37
    v_fma_f32 v248, v210, v246, v11
    v_fma_f32 v249, v210, v247, v27
    v_mul_f32 v202, 0xbfb8aa3b, v38
    v_fma_f32 v248, -v211, v247, v248
    v_fma_f32 v249, v211, v246, v249
    v_mul_f32 v203, 0xbfb8aa3b, v39
    v_fma_f32 v246, v210, v248, v12
    v_fma_f32 v247, v210, v249, v28
    v_exp_f32 v200, v200
    v_fma_f32 v246, -v211, v249, v246
    v_fma_f32 v247, v211, v248, v247
    v_exp_f32 v201, v201
    v_fma_f32 v248, v210, v246, v13
    v_fma_f32 v249, v210, v247, v29
    v_exp_f32 v202, v202
    v_fma_f32 v248, -v211, v247, v248
    v_fma_f32 v249, v211, v246, v249
    v_exp_f32 v203, v203
    v_fma_f32 v246, v210, v248, v14
    v_fma_f32 v247, v210, v249, v30
    v_mul_f32 v44, v36, v44
    v_fma_f32 v246, -v211, v249, v246
    v_fma_f32 v247, v211, v248, v247
    v_mul_f32 v45, v37, v45
    v_fma_f32 v248, v210, v246, v15
    v_fma_f32 v249, v210, v247, v31
    v_mul_f32 v46, v38, v46
    v_fma_f32 v248, -v211, v247, v248
    v_fma_f32 v249, v211, v246, v249
    v_mul_f32 v47, v39, v47
    v_mul_f32 v252, v248, v218
    v_mul_f32 v253, v248, v219
    v_add_f32 v200, 1.0, v200
    v_fma_f32 v252, -v249, v219, v252
    v_fma_f32 v251, v249, v218, v253
    v_add_f32 v201, 1.0, v201
    v_mov_b32 v250, v252
    ds_write_b64 v226, v[250:251]
    v_add_f32 v202, 1.0, v202
    buffer_load_dwordx4 v[252:255], v232, s[44:47], 0 offen sc1
    s_waitcnt lgkmcnt(0)
    s_barrier
    ds_read_b64_tr_b16 v[144:145], v239 offset:61440
    ds_read_b64_tr_b16 v[146:147], v239 offset:61952
    v_mov_b32 v250, s4
    v_add_f32 v203, 1.0, v203
    v_mov_b32 v251, s5
    ds_read_b64 v[184:185], v227 offset:0
    v_mfma_f32_32x32x16_bf16 v[112:127], v[152:155], a[144:147], v[112:127]
    ds_read_b64_tr_b16 v[148:149], v240 offset:61440
    ds_read_b64_tr_b16 v[150:151], v240 offset:61952
    v_rcp_f32 v200, v200
    ds_read_b64 v[186:187], v227 offset:256
    ds_read_b64 v[188:189], v227 offset:512
    v_mfma_f32_32x32x16_bf16 v[128:143], v[156:159], a[16:19], v[128:143]
    v_rcp_f32 v201, v201
    ds_read_b64 v[190:191], v227 offset:768
    ds_read_b64 v[192:193], v227 offset:1024
    v_rcp_f32 v202, v202
    v_mfma_f32_32x32x16_bf16 v[168:183], v[156:159], a[144:147], v[168:183]
    ds_read_b64 v[194:195], v227 offset:1280
    ds_read_b64 v[196:197], v227 offset:1536
    v_rcp_f32 v203, v203
    ds_read_b64 v[198:199], v227 offset:1792
    v_mov_b32 v222, 0
    v_mfma_f32_32x32x16_bf16 v[96:111], v[160:163], a[20:23], v[96:111]
    ds_read_b64_tr_b16 v[152:153], v239 offset:63488
    ds_read_b64_tr_b16 v[154:155], v239 offset:64000
    v_mul_f32 v44, v44, v200
    v_mov_b32 v223, 0
    v_cmp_eq_u32 vcc, 1, v231
    v_mul_f32 v45, v45, v201
    v_mfma_f32_32x32x16_bf16 v[112:127], v[160:163], a[148:151], v[112:127]
    ds_read_b64_tr_b16 v[156:157], v240 offset:63488
    ds_read_b64_tr_b16 v[158:159], v240 offset:64000
    s_waitcnt lgkmcnt(10)
    v_fma_f32 v248, v212, v184, v186
    v_fma_f32 v249, v212, v185, v187
    v_mul_f32 v46, v46, v202
    v_mfma_f32_32x32x16_bf16 v[128:143], v[164:167], a[20:23], v[128:143]
    v_cndmask_b32 v222, v222, v184, vcc
    v_cndmask_b32 v223, v223, v185, vcc
    v_mul_f32 v47, v47, v203
    v_fma_f32 v248, -v213, v185, v248
    v_fma_f32 v249, v213, v184, v249
    v_cvt_pk_bf16_f32 v34, v44, v45
    v_mfma_f32_32x32x16_bf16 v[168:183], v[164:167], a[148:151], v[168:183]
    v_cmp_eq_u32 vcc, 2, v231
    s_waitcnt lgkmcnt(9)
    v_fma_f32 v246, v212, v248, v188
    v_cvt_pk_bf16_f32 v35, v46, v47
    v_fma_f32 v247, v212, v249, v189
    v_cndmask_b32 v222, v222, v248, vcc
    v_mfma_f32_32x32x16_bf16 v[96:111], v[144:147], a[24:27], v[96:111]
    s_waitcnt vmcnt(18)
    s_waitcnt lgkmcnt(0)
    s_barrier
    ds_read_b64_tr_b16 v[160:161], v239 offset:0
    ds_read_b64_tr_b16 v[162:163], v239 offset:512
    buffer_store_dwordx4 v[32:35], v224, s[44:47], s13 offen sc1
    v_cndmask_b32 v223, v223, v249, vcc
    v_fma_f32 v246, -v213, v249, v246
    v_mfma_f32_32x32x16_bf16 v[112:127], v[144:147], a[152:155], v[112:127]
    ds_read_b64_tr_b16 v[164:165], v240 offset:0
    ds_read_b64_tr_b16 v[166:167], v240 offset:512
    v_fma_f32 v247, v213, v248, v247
    v_cmp_eq_u32 vcc, 3, v231
    v_mul_f32 v200, 0xbfb8aa3b, v48
    v_fma_f32 v248, v212, v246, v190
    v_mfma_f32_32x32x16_bf16 v[128:143], v[148:151], a[24:27], v[128:143]
    v_fma_f32 v249, v212, v247, v191
    v_mul_f32 v201, 0xbfb8aa3b, v49
    v_cndmask_b32 v222, v222, v246, vcc
    v_cndmask_b32 v223, v223, v247, vcc
    v_mul_f32 v202, 0xbfb8aa3b, v50
    v_fma_f32 v248, -v213, v247, v248
    v_mfma_f32_32x32x16_bf16 v[168:183], v[148:151], a[152:155], v[168:183]
    v_fma_f32 v249, v213, v246, v249
    v_mul_f32 v203, 0xbfb8aa3b, v51
    v_cmp_eq_u32 vcc, 4, v231
    v_fma_f32 v246, v212, v248, v192
    v_exp_f32 v200, v200
    v_mfma_f32_32x32x16_bf16 v[96:111], v[152:155], a[28:31], v[96:111]
    ds_read_b64_tr_b16 v[144:145], v239 offset:2048
    ds_read_b64_tr_b16 v[146:147], v239 offset:2560
    v_fma_f32 v247, v212, v249, v193
    v_cndmask_b32 v222, v222, v248, vcc
    v_exp_f32 v201, v201
    v_mfma_f32_32x32x16_bf16 v[112:127], v[152:155], a[156:159], v[112:127]
    ds_read_b64_tr_b16 v[148:149], v240 offset:2048
    ds_read_b64_tr_b16 v[150:151], v240 offset:2560
    v_cndmask_b32 v223, v223, v249, vcc
    v_fma_f32 v246, -v213, v249, v246
    v_exp_f32 v202, v202
    v_mfma_f32_32x32x16_bf16 v[128:143], v[156:159], a[28:31], v[128:143]
    v_fma_f32 v247, v213, v248, v247
    v_cmp_eq_u32 vcc, 5, v231
    v_exp_f32 v203, v203
    v_fma_f32 v248, v212, v246, v194
    v_fma_f32 v249, v212, v247, v195
    v_mfma_f32_32x32x16_bf16 v[168:183], v[156:159], a[156:159], v[168:183]
    v_mul_f32 v56, v48, v56
    v_cndmask_b32 v222, v222, v246, vcc
    v_cndmask_b32 v223, v223, v247, vcc
    v_mul_f32 v57, v49, v57
    v_fma_f32 v248, -v213, v247, v248
    v_fma_f32 v249, v213, v246, v249
    s_waitcnt lgkmcnt(4)
    v_mfma_f32_32x32x16_bf16 v[96:111], v[160:163], a[32:35], v[96:111]
    ds_read_b64_tr_b16 v[152:153], v239 offset:4096
    ds_read_b64_tr_b16 v[154:155], v239 offset:4608
    v_mul_f32 v58, v50, v58
    v_cmp_eq_u32 vcc, 6, v231
    v_fma_f32 v246, v212, v248, v196
    v_mul_f32 v59, v51, v59
    v_mfma_f32_32x32x16_bf16 v[112:127], v[160:163], a[160:163], v[112:127]
    ds_read_b64_tr_b16 v[156:157], v240 offset:4096
    ds_read_b64_tr_b16 v[158:159], v240 offset:4608
    v_fma_f32 v247, v212, v249, v197
    v_cndmask_b32 v222, v222, v248, vcc
    v_add_f32 v200, 1.0, v200
    v_cndmask_b32 v223, v223, v249, vcc
    v_mfma_f32_32x32x16_bf16 v[128:143], v[164:167], a[32:35], v[128:143]
    v_fma_f32 v246, -v213, v249, v246
    v_add_f32 v201, 1.0, v201
    v_fma_f32 v247, v213, v248, v247
    v_cmp_eq_u32 vcc, 7, v231
    v_add_f32 v202, 1.0, v202
    v_fma_f32 v248, v212, v246, v198
    v_mfma_f32_32x32x16_bf16 v[168:183], v[164:167], a[160:163], v[168:183]
    v_fma_f32 v249, v212, v247, v199
    v_add_f32 v203, 1.0, v203
    v_cndmask_b32 v222, v222, v246, vcc
    v_cndmask_b32 v223, v223, v247, vcc
    v_rcp_f32 v200, v200
    s_waitcnt lgkmcnt(4)
    v_mfma_f32_32x32x16_bf16 v[96:111], v[144:147], a[36:39], v[96:111]
    ds_read_b64_tr_b16 v[160:161], v239 offset:6144
    ds_read_b64_tr_b16 v[162:163], v239 offset:6656
    v_fma_f32 v248, -v213, v247, v248
    v_fma_f32 v249, v213, v246, v249
    v_rcp_f32 v201, v201
    v_mfma_f32_32x32x16_bf16 v[112:127], v[144:147], a[164:167], v[112:127]
    ds_read_b64_tr_b16 v[164:165], v240 offset:6144
    ds_read_b64_tr_b16 v[166:167], v240 offset:6656
    buffer_store_dwordx4 v[248:251], v228, s[52:55], 0 offen sc1
    s_waitcnt vmcnt(2)
    s_mov_b32 s3, 0
fused_kernel_fw_chk:
    v_cmp_eq_u64 s[20:21], s[4:5], v[252:253]
    v_cmp_eq_u64 s[22:23], s[4:5], v[254:255]
    s_nop 1
    s_and_b64 s[20:21], s[20:21], s[22:23]
    s_cmp_eq_u64 s[20:21], -1
    s_cbranch_scc1 fused_kernel_fw_ok
fused_kernel_fw_retry:
    s_add_u32 s3, s3, 1
    s_cmp_gt_u32 s3, 0x40000
    s_cbranch_scc1 fused_kernel_fw_ok
    s_sleep 4
    buffer_load_dwordx4 v[252:255], v232, s[44:47], 0 offen sc1
    s_waitcnt vmcnt(0)
    s_branch fused_kernel_fw_chk
fused_kernel_fw_ok:
    v_mfma_f32_32x32x16_bf16 v[128:143], v[148:151], a[36:39], v[128:143]
    s_mul_i32 s50, s64, 57344
    s_add_u32 s50, s50, 131072
    buffer_load_dwordx4 a[0:3], v206, s[44:47], s50 offen sc1
    v_rcp_f32 v202, v202
    v_mfma_f32_32x32x16_bf16 v[168:183], v[148:151], a[164:167], v[168:183]
    buffer_load_dwordx4 a[128:131], v207, s[44:47], s50 offen sc1
    v_lshrrev_b32 v252, 4, v209
    v_mov_b32 v250, s4
    v_rcp_f32 v203, v203
    s_waitcnt lgkmcnt(4)
    v_mfma_f32_32x32x16_bf16 v[96:111], v[152:155], a[40:43], v[96:111]
    ds_read_b64_tr_b16 v[144:145], v239 offset:16384
    ds_read_b64_tr_b16 v[146:147], v239 offset:16896
    v_mov_b32 v251, s5
    v_cmp_gt_u32 vcc, s67, v252
    v_mul_f32 v56, v56, v200
    v_add_u32 v252, 4, v252
    v_mfma_f32_32x32x16_bf16 v[112:127], v[152:155], a[168:171], v[112:127]
    ds_read_b64_tr_b16 v[148:149], v240 offset:16384
    ds_read_b64_tr_b16 v[150:151], v240 offset:16896
    v_cndmask_b32 v184, 0, v250, vcc
    v_mul_f32 v57, v57, v201
    v_cndmask_b32 v185, 0, v251, vcc
    v_cmp_gt_u32 vcc, s67, v252
    v_mfma_f32_32x32x16_bf16 v[128:143], v[156:159], a[40:43], v[128:143]
    buffer_load_dwordx4 a[4:7], v206, s[44:47], s50 offen offset:2048 sc1
    v_mul_f32 v58, v58, v202
    v_add_u32 v252, 4, v252
    v_cndmask_b32 v186, 0, v250, vcc
    v_mul_f32 v59, v59, v203
    v_mfma_f32_32x32x16_bf16 v[168:183], v[156:159], a[168:171], v[168:183]
    v_cndmask_b32 v187, 0, v251, vcc
    v_cmp_gt_u32 vcc, s67, v252
    v_cvt_pk_bf16_f32 v48, v56, v57
    v_add_u32 v252, 4, v252
    v_cndmask_b32 v188, 0, v250, vcc
    v_cvt_pk_bf16_f32 v49, v58, v59
    s_waitcnt lgkmcnt(4)
    v_mfma_f32_32x32x16_bf16 v[96:111], v[160:163], a[44:47], v[96:111]
    buffer_load_dwordx4 a[132:135], v207, s[44:47], s50 offen offset:2048 sc1
    ds_read_b64_tr_b16 v[152:153], v239 offset:18432
    ds_read_b64_tr_b16 v[154:155], v239 offset:18944
    v_cndmask_b32 v189, 0, v251, vcc
    v_cmp_gt_u32 vcc, s67, v252
    v_mfma_f32_32x32x16_bf16 v[112:127], v[160:163], a[172:175], v[112:127]
    ds_read_b64_tr_b16 v[156:157], v240 offset:18432
    ds_read_b64_tr_b16 v[158:159], v240 offset:18944
    v_mul_f32 v200, 0xbfb8aa3b, v52
    v_add_u32 v252, 4, v252
    v_cndmask_b32 v190, 0, v250, vcc
    v_mul_f32 v201, 0xbfb8aa3b, v53
    v_mfma_f32_32x32x16_bf16 v[128:143], v[164:167], a[44:47], v[128:143]
    v_cndmask_b32 v191, 0, v251, vcc
    v_mul_f32 v202, 0xbfb8aa3b, v54
    v_mul_f32 v32, v218, v16
    v_fma_f32 v32, v219, v0, v32
    v_mul_f32 v203, 0xbfb8aa3b, v55
    v_mul_f32 v0, v218, v0
    v_mfma_f32_32x32x16_bf16 v[168:183], v[164:167], a[172:175], v[168:183]
    s_add_u32 s50, s50, 4096
    buffer_load_dwordx4 a[8:11], v206, s[44:47], s50 offen sc1
    v_fma_f32 v0, -v219, v16, v0
    v_exp_f32 v200, v200
    s_waitcnt lgkmcnt(4)
    v_mfma_f32_32x32x16_bf16 v[96:111], v[144:147], a[48:51], v[96:111]
    ds_read_b64_tr_b16 v[160:161], v239 offset:20480
    ds_read_b64_tr_b16 v[162:163], v239 offset:20992
    v_mul_f32 v33, v218, v17
    v_fma_f32 v33, v219, v1, v33
    v_exp_f32 v201, v201
    v_mfma_f32_32x32x16_bf16 v[112:127], v[144:147], a[176:179], v[112:127]
    ds_read_b64_tr_b16 v[164:165], v240 offset:20480
    ds_read_b64_tr_b16 v[166:167], v240 offset:20992
    v_mul_f32 v1, v218, v1
    v_fma_f32 v1, -v219, v17, v1
    v_exp_f32 v202, v202
    v_mfma_f32_32x32x16_bf16 v[128:143], v[148:151], a[48:51], v[128:143]
    buffer_load_dwordx4 a[136:139], v207, s[44:47], s50 offen sc1
    v_mul_f32 v34, v218, v18
    v_fma_f32 v34, v219, v2, v34
    v_exp_f32 v203, v203
    v_mfma_f32_32x32x16_bf16 v[168:183], v[148:151], a[176:179], v[168:183]
    v_mul_f32 v2, v218, v2
    v_fma_f32 v2, -v219, v18, v2
    v_mul_f32 v60, v52, v60
    v_mul_f32 v35, v218, v19
    v_fma_f32 v35, v219, v3, v35
    v_mul_f32 v61, v53, v61
    s_waitcnt lgkmcnt(4)
    v_mfma_f32_32x32x16_bf16 v[96:111], v[152:155], a[52:55], v[96:111]
    ds_read_b64_tr_b16 v[144:145], v239 offset:22528
    ds_read_b64_tr_b16 v[146:147], v239 offset:23040
    v_mul_f32 v3, v218, v3
    v_fma_f32 v3, -v219, v19, v3
    v_mul_f32 v62, v54, v62
    v_mul_f32 v36, v218, v20
    v_mfma_f32_32x32x16_bf16 v[112:127], v[152:155], a[180:183], v[112:127]
    buffer_load_dwordx4 a[12:15], v206, s[44:47], s50 offen offset:2048 sc1
    ds_read_b64_tr_b16 v[148:149], v240 offset:22528
    ds_read_b64_tr_b16 v[150:151], v240 offset:23040
    v_fma_f32 v36, v219, v4, v36
    v_mul_f32 v63, v55, v63
    v_mfma_f32_32x32x16_bf16 v[128:143], v[156:159], a[52:55], v[128:143]
    v_mul_f32 v4, v218, v4
    v_fma_f32 v4, -v219, v20, v4
    v_add_f32 v200, 1.0, v200
    v_mul_f32 v37, v218, v21
    v_fma_f32 v37, v219, v5, v37
    v_add_f32 v201, 1.0, v201
    v_mfma_f32_32x32x16_bf16 v[168:183], v[156:159], a[180:183], v[168:183]
    buffer_load_dwordx4 a[140:143], v207, s[44:47], s50 offen offset:2048 sc1
    v_mul_f32 v5, v218, v5
    v_fma_f32 v5, -v219, v21, v5
    v_add_f32 v202, 1.0, v202
    v_mul_f32 v38, v218, v22
    s_waitcnt lgkmcnt(4)
    v_mfma_f32_32x32x16_bf16 v[96:111], v[160:163], a[56:59], v[96:111]
    s_waitcnt lgkmcnt(0)
    s_barrier
    ds_read_b64_tr_b16 v[152:153], v237 offset:0
    ds_read_b64_tr_b16 v[154:155], v237 offset:512
    v_fma_f32 v38, v219, v6, v38
    v_add_f32 v203, 1.0, v203
    v_mul_f32 v6, v218, v6
    v_fma_f32 v6, -v219, v22, v6
    v_mfma_f32_32x32x16_bf16 v[112:127], v[160:163], a[184:187], v[112:127]
    ds_read_b64_tr_b16 v[156:157], v238 offset:0
    ds_read_b64_tr_b16 v[158:159], v238 offset:512
    v_rcp_f32 v200, v200
    v_mul_f32 v39, v218, v23
    v_fma_f32 v39, v219, v7, v39
    v_mfma_f32_32x32x16_bf16 v[128:143], v[164:167], a[56:59], v[128:143]
    s_add_u32 s50, s50, 4096
    buffer_load_dwordx4 a[16:19], v206, s[44:47], s50 offen sc1
    v_rcp_f32 v201, v201
    v_mul_f32 v7, v218, v7
    v_mfma_f32_32x32x16_bf16 v[168:183], v[164:167], a[184:187], v[168:183]
    v_fma_f32 v7, -v219, v23, v7
    v_rcp_f32 v202, v202
    v_mul_f32 v40, v218, v24
    v_fma_f32 v40, v219, v8, v40
    v_rcp_f32 v203, v203
    v_mfma_f32_32x32x16_bf16 v[96:111], v[144:147], a[60:63], v[96:111]
    ds_read_b64_tr_b16 v[160:161], v237 offset:2048
    ds_read_b64_tr_b16 v[162:163], v237 offset:2560
    v_mul_f32 v8, v218, v8
    v_fma_f32 v8, -v219, v24, v8
    v_mul_f32 v60, v60, v200
    v_mul_f32 v41, v218, v25
    v_mfma_f32_32x32x16_bf16 v[112:127], v[144:147], a[188:191], v[112:127]
    buffer_load_dwordx4 a[144:147], v207, s[44:47], s50 offen sc1
    ds_read_b64_tr_b16 v[164:165], v238 offset:2048
    ds_read_b64_tr_b16 v[166:167], v238 offset:2560
    v_fma_f32 v41, v219, v9, v41
    v_mul_f32 v61, v61, v201
    v_mfma_f32_32x32x16_bf16 v[128:143], v[148:151], a[60:63], v[128:143]
    v_mul_f32 v9, v218, v9
    v_fma_f32 v9, -v219, v25, v9
    v_mul_f32 v62, v62, v202
    v_mul_f32 v42, v218, v26
    v_fma_f32 v42, v219, v10, v42
    v_mul_f32 v63, v63, v203
    v_mfma_f32_32x32x16_bf16 v[168:183], v[148:151], a[188:191], v[168:183]
    v_mul_f32 v10, v218, v10
    v_fma_f32 v10, -v219, v26, v10
    v_cvt_pk_bf16_f32 v50, v60, v61
    v_mul_f32 v43, v218, v27
    v_fma_f32 v43, v219, v11, v43
    v_cvt_pk_bf16_f32 v51, v62, v63
    s_waitcnt lgkmcnt(4)
    v_mfma_f32_32x32x16_bf16 v[96:111], v[152:155], a[64:67], v[96:111]
    buffer_load_dwordx4 a[20:23], v206, s[44:47], s50 offen offset:2048 sc1
    ds_read_b64_tr_b16 v[144:145], v237 offset:4096
    ds_read_b64_tr_b16 v[146:147], v237 offset:4608
    v_mul_f32 v11, v218, v11
    v_fma_f32 v11, -v219, v27, v11
    v_mfma_f32_32x32x16_bf16 v[112:127], v[152:155], a[192:195], v[112:127]
    ds_read_b64_tr_b16 v[148:149], v238 offset:4096
    ds_read_b64_tr_b16 v[150:151], v238 offset:4608
    buffer_store_dwordx4 v[48:51], v225, s[44:47], s13 offen sc1
    v_mul_f32 v44, v218, v28
    v_fma_f32 v44, v219, v12, v44
    v_mfma_f32_32x32x16_bf16 v[128:143], v[156:159], a[64:67], v[128:143]
    buffer_load_dwordx4 a[148:151], v207, s[44:47], s50 offen offset:2048 sc1
    v_mul_f32 v200, 0xbfb8aa3b, v64
    v_mul_f32 v12, v218, v12
    v_fma_f32 v12, -v219, v28, v12
    v_mul_f32 v201, 0xbfb8aa3b, v65
    v_mfma_f32_32x32x16_bf16 v[168:183], v[156:159], a[192:195], v[168:183]
    v_mul_f32 v45, v218, v29
    v_fma_f32 v45, v219, v13, v45
    v_mul_f32 v202, 0xbfb8aa3b, v66
    v_mul_f32 v13, v218, v13
    v_fma_f32 v13, -v219, v29, v13
    v_mul_f32 v203, 0xbfb8aa3b, v67
    s_waitcnt lgkmcnt(4)
    v_mfma_f32_32x32x16_bf16 v[96:111], v[160:163], a[68:71], v[96:111]
    ds_read_b64_tr_b16 v[152:153], v237 offset:6144
    ds_read_b64_tr_b16 v[154:155], v237 offset:6656
    v_mul_f32 v46, v218, v30
    v_fma_f32 v46, v219, v14, v46
    v_exp_f32 v200, v200
    v_mfma_f32_32x32x16_bf16 v[112:127], v[160:163], a[196:199], v[112:127]
    s_add_u32 s50, s50, 4096
    buffer_load_dwordx4 a[24:27], v206, s[44:47], s50 offen sc1
    ds_read_b64_tr_b16 v[156:157], v238 offset:6144
    ds_read_b64_tr_b16 v[158:159], v238 offset:6656
    v_mul_f32 v14, v218, v14
    v_mfma_f32_32x32x16_bf16 v[128:143], v[164:167], a[68:71], v[128:143]
    v_fma_f32 v14, -v219, v30, v14
    v_exp_f32 v201, v201
    v_mul_f32 v47, v218, v31
    v_fma_f32 v47, v219, v15, v47
    v_exp_f32 v202, v202
    v_mfma_f32_32x32x16_bf16 v[168:183], v[164:167], a[196:199], v[168:183]
    v_mul_f32 v15, v218, v15
    v_fma_f32 v15, -v219, v31, v15
    v_exp_f32 v203, v203
    v_mul_f32 v72, v64, v72
    v_mul_f32 v73, v65, v73
    s_waitcnt lgkmcnt(4)
    v_mfma_f32_32x32x16_bf16 v[96:111], v[144:147], a[72:75], v[96:111]
    buffer_load_dwordx4 a[152:155], v207, s[44:47], s50 offen sc1
    ds_read_b64_tr_b16 v[160:161], v237 offset:16384
    ds_read_b64_tr_b16 v[162:163], v237 offset:16896
    v_mul_f32 v74, v66, v74
    buffer_load_dwordx4 v[16:19], v230, s[52:55], 0 offen offset:0 sc1
    buffer_load_dwordx4 v[20:23], v230, s[52:55], 0 offen offset:2048 sc1
    buffer_load_dwordx4 v[24:27], v208, s[52:55], 0 offen offset:0 sc1
    buffer_load_dwordx4 v[28:31], v208, s[52:55], 0 offen offset:2048 sc1
    v_mfma_f32_32x32x16_bf16 v[112:127], v[144:147], a[200:203], v[112:127]
    ds_read_b64_tr_b16 v[164:165], v238 offset:16384
    ds_read_b64_tr_b16 v[166:167], v238 offset:16896
    v_mul_f32 v75, v67, v75
    v_add_f32 v200, 1.0, v200
    v_add_f32 v201, 1.0, v201
    v_add_f32 v202, 1.0, v202
    v_mfma_f32_32x32x16_bf16 v[128:143], v[148:151], a[72:75], v[128:143]
    v_add_f32 v203, 1.0, v203
    v_rcp_f32 v200, v200
    v_rcp_f32 v201, v201
    v_rcp_f32 v202, v202
    v_mfma_f32_32x32x16_bf16 v[168:183], v[148:151], a[200:203], v[168:183]
    buffer_load_dwordx4 a[28:31], v206, s[44:47], s50 offen offset:2048 sc1
    v_rcp_f32 v203, v203
    v_mul_f32 v72, v72, v200
    v_mul_f32 v73, v73, v201
    s_waitcnt lgkmcnt(4)
    v_mfma_f32_32x32x16_bf16 v[96:111], v[152:155], a[76:79], v[96:111]
    ds_read_b64_tr_b16 v[144:145], v237 offset:18432
    ds_read_b64_tr_b16 v[146:147], v237 offset:18944
    v_mul_f32 v74, v74, v202
    v_mul_f32 v75, v75, v203
    v_cvt_pk_bf16_f32 v64, v72, v73
    v_cvt_pk_bf16_f32 v65, v74, v75
    v_mfma_f32_32x32x16_bf16 v[112:127], v[152:155], a[204:207], v[112:127]
    buffer_load_dwordx4 a[156:159], v207, s[44:47], s50 offen offset:2048 sc1
    ds_read_b64_tr_b16 v[148:149], v238 offset:18432
    ds_read_b64_tr_b16 v[150:151], v238 offset:18944
    v_mul_f32 v200, 0xbfb8aa3b, v68
    v_mul_f32 v201, 0xbfb8aa3b, v69
    v_mfma_f32_32x32x16_bf16 v[128:143], v[156:159], a[76:79], v[128:143]
    v_mul_f32 v202, 0xbfb8aa3b, v70
    v_mul_f32 v203, 0xbfb8aa3b, v71
    v_exp_f32 v200, v200
    v_exp_f32 v201, v201
    v_mfma_f32_32x32x16_bf16 v[168:183], v[156:159], a[204:207], v[168:183]
    v_exp_f32 v202, v202
    v_exp_f32 v203, v203
    v_mul_f32 v76, v68, v76
    v_mul_f32 v77, v69, v77
    s_waitcnt lgkmcnt(4)
    v_mfma_f32_32x32x16_bf16 v[96:111], v[160:163], a[80:83], v[96:111]
    s_add_u32 s50, s50, 4096
    buffer_load_dwordx4 a[32:35], v206, s[44:47], s50 offen sc1
    ds_read_b64_tr_b16 v[152:153], v237 offset:20480
    ds_read_b64_tr_b16 v[154:155], v237 offset:20992
    v_mul_f32 v78, v70, v78
    v_mfma_f32_32x32x16_bf16 v[112:127], v[160:163], a[208:211], v[112:127]
    ds_read_b64_tr_b16 v[156:157], v238 offset:20480
    ds_read_b64_tr_b16 v[158:159], v238 offset:20992
    v_mul_f32 v79, v71, v79
    v_add_f32 v200, 1.0, v200
    v_add_f32 v201, 1.0, v201
    v_add_f32 v202, 1.0, v202
    v_mfma_f32_32x32x16_bf16 v[128:143], v[164:167], a[80:83], v[128:143]
    v_add_f32 v203, 1.0, v203
    v_rcp_f32 v200, v200
    v_rcp_f32 v201, v201
    v_rcp_f32 v202, v202
    v_mfma_f32_32x32x16_bf16 v[168:183], v[164:167], a[208:211], v[168:183]
    buffer_load_dwordx4 a[160:163], v207, s[44:47], s50 offen sc1
    v_rcp_f32 v203, v203
    v_mul_f32 v76, v76, v200
    v_mul_f32 v77, v77, v201
    s_waitcnt lgkmcnt(4)
    v_mfma_f32_32x32x16_bf16 v[96:111], v[144:147], a[84:87], v[96:111]
    ds_read_b64_tr_b16 v[160:161], v237 offset:22528
    ds_read_b64_tr_b16 v[162:163], v237 offset:23040
    v_mul_f32 v78, v78, v202
    v_mul_f32 v79, v79, v203
    v_cvt_pk_bf16_f32 v66, v76, v77
    v_cvt_pk_bf16_f32 v67, v78, v79
    v_mfma_f32_32x32x16_bf16 v[112:127], v[144:147], a[212:215], v[112:127]
    ds_read_b64_tr_b16 v[164:165], v238 offset:22528
    ds_read_b64_tr_b16 v[166:167], v238 offset:23040
    buffer_store_dwordx4 v[64:67], v224, s[44:47], s13 offen offset:2048 sc1
    v_mul_f32 v200, 0xbfb8aa3b, v80
    v_mul_f32 v201, 0xbfb8aa3b, v81
    v_mfma_f32_32x32x16_bf16 v[128:143], v[148:151], a[84:87], v[128:143]
    buffer_load_dwordx4 a[36:39], v206, s[44:47], s50 offen offset:2048 sc1
    v_mul_f32 v202, 0xbfb8aa3b, v82
    v_mul_f32 v203, 0xbfb8aa3b, v83
    v_exp_f32 v200, v200
    v_mfma_f32_32x32x16_bf16 v[168:183], v[148:151], a[212:215], v[168:183]
    v_exp_f32 v201, v201
    v_exp_f32 v202, v202
    v_exp_f32 v203, v203
    s_waitcnt lgkmcnt(4)
    v_mfma_f32_32x32x16_bf16 v[96:111], v[152:155], a[88:91], v[96:111]
    s_waitcnt lgkmcnt(0)
    s_barrier
    buffer_load_dwordx4 a[164:167], v207, s[44:47], s50 offen offset:2048 sc1
    ds_read_b64_tr_b16 v[144:145], v237 offset:40960
    ds_read_b64_tr_b16 v[146:147], v237 offset:41472
    v_mul_f32 v88, v80, v88
    v_mul_f32 v89, v81, v89
    v_mfma_f32_32x32x16_bf16 v[112:127], v[152:155], a[216:219], v[112:127]
    ds_read_b64_tr_b16 v[148:149], v238 offset:40960
    ds_read_b64_tr_b16 v[150:151], v238 offset:41472
    v_mul_f32 v90, v82, v90
    v_mul_f32 v91, v83, v91
    v_add_f32 v200, 1.0, v200
    v_add_f32 v201, 1.0, v201
    v_mfma_f32_32x32x16_bf16 v[128:143], v[156:159], a[88:91], v[128:143]
    v_add_f32 v202, 1.0, v202
    v_add_f32 v203, 1.0, v203
    v_rcp_f32 v200, v200
    v_rcp_f32 v201, v201
    v_mfma_f32_32x32x16_bf16 v[168:183], v[156:159], a[216:219], v[168:183]
    s_add_u32 s50, s50, 4096
    buffer_load_dwordx4 a[40:43], v206, s[44:47], s50 offen sc1
    v_rcp_f32 v202, v202
    v_rcp_f32 v203, v203
    v_mfma_f32_32x32x16_bf16 v[96:111], v[160:163], a[92:95], v[96:111]
    ds_read_b64_tr_b16 v[152:153], v237 offset:43008
    ds_read_b64_tr_b16 v[154:155], v237 offset:43520
    v_mul_f32 v88, v88, v200
    v_mul_f32 v89, v89, v201
    v_mul_f32 v90, v90, v202
    v_mul_f32 v91, v91, v203
    v_mfma_f32_32x32x16_bf16 v[112:127], v[160:163], a[220:223], v[112:127]
    ds_read_b64_tr_b16 v[156:157], v238 offset:43008
    ds_read_b64_tr_b16 v[158:159], v238 offset:43520
    v_cvt_pk_bf16_f32 v80, v88, v89
    v_cvt_pk_bf16_f32 v81, v90, v91
    v_mul_f32 v200, 0xbfb8aa3b, v84
    v_mul_f32 v201, 0xbfb8aa3b, v85
    v_mfma_f32_32x32x16_bf16 v[128:143], v[164:167], a[92:95], v[128:143]
    buffer_load_dwordx4 a[168:171], v207, s[44:47], s50 offen sc1
    v_mul_f32 v202, 0xbfb8aa3b, v86
    v_mul_f32 v203, 0xbfb8aa3b, v87
    v_exp_f32 v200, v200
    v_mfma_f32_32x32x16_bf16 v[168:183], v[164:167], a[220:223], v[168:183]
    v_exp_f32 v201, v201
    v_exp_f32 v202, v202
    v_exp_f32 v203, v203
    s_waitcnt lgkmcnt(4)
    v_mfma_f32_32x32x16_bf16 v[96:111], v[144:147], a[96:99], v[96:111]
    ds_read_b64_tr_b16 v[160:161], v237 offset:45056
    ds_read_b64_tr_b16 v[162:163], v237 offset:45568
    s_waitcnt vmcnt(9)
    s_mov_b32 s3, 0
fused_kernel_e_chk:
    v_cmp_eq_u64 s[20:21], v[184:185], v[18:19]
    v_cmp_eq_u64 s[22:23], v[186:187], v[22:23]
    v_cmp_eq_u64 s[70:71], v[188:189], v[26:27]
    v_cmp_eq_u64 s[72:73], v[190:191], v[30:31]
    s_and_b64 s[20:21], s[20:21], s[22:23]
    s_nop 0
    s_and_b64 s[70:71], s[70:71], s[72:73]
    s_and_b64 s[20:21], s[20:21], s[70:71]
    s_cmp_eq_u64 s[20:21], -1
    s_cbranch_scc1 fused_kernel_e_ok
fused_kernel_e_retry:
    s_add_u32 s3, s3, 1
    s_cmp_gt_u32 s3, 0x40000
    s_cbranch_scc1 fused_kernel_e_ok
    s_sleep 4
    buffer_load_dwordx4 v[16:19], v230, s[52:55], 0 offen offset:0 sc1
    buffer_load_dwordx4 v[20:23], v230, s[52:55], 0 offen offset:2048 sc1
    buffer_load_dwordx4 v[24:27], v208, s[52:55], 0 offen offset:0 sc1
    buffer_load_dwordx4 v[28:31], v208, s[52:55], 0 offen offset:2048 sc1
    s_waitcnt vmcnt(0)
    s_branch fused_kernel_e_chk
fused_kernel_e_ok:
    v_mfma_f32_32x32x16_bf16 v[112:127], v[144:147], a[224:227], v[112:127]
    buffer_load_dwordx4 a[44:47], v206, s[44:47], s50 offen offset:2048 sc1
    ds_read_b64_tr_b16 v[164:165], v238 offset:45056
    ds_read_b64_tr_b16 v[166:167], v238 offset:45568
    v_mul_f32 v92, v84, v92
    v_fma_f32 v246, v214, v28, v24
    v_mfma_f32_32x32x16_bf16 v[128:143], v[148:151], a[96:99], v[128:143]
    v_fma_f32 v247, v214, v29, v25
    v_mul_f32 v93, v85, v93
    v_fma_f32 v246, -v215, v29, v246
    v_fma_f32 v247, v215, v28, v247
    v_mul_f32 v94, v86, v94
    v_fma_f32 v248, v214, v246, v20
    v_mfma_f32_32x32x16_bf16 v[168:183], v[148:151], a[224:227], v[168:183]
    buffer_load_dwordx4 a[172:175], v207, s[44:47], s50 offen offset:2048 sc1
    v_fma_f32 v249, v214, v247, v21
    v_mul_f32 v95, v87, v95
    v_fma_f32 v248, -v215, v247, v248
    v_fma_f32 v249, v215, v246, v249
    s_waitcnt lgkmcnt(4)
    v_mfma_f32_32x32x16_bf16 v[96:111], v[152:155], a[100:103], v[96:111]
    ds_read_b64_tr_b16 v[144:145], v237 offset:47104
    ds_read_b64_tr_b16 v[146:147], v237 offset:47616
    v_add_f32 v200, 1.0, v200
    v_fma_f32 v246, v214, v248, v16
    v_fma_f32 v247, v214, v249, v17
    v_add_f32 v201, 1.0, v201
    v_mfma_f32_32x32x16_bf16 v[112:127], v[152:155], a[228:231], v[112:127]
    ds_read_b64_tr_b16 v[148:149], v238 offset:47104
    ds_read_b64_tr_b16 v[150:151], v238 offset:47616
    v_fma_f32 v246, -v215, v249, v246
    v_fma_f32 v247, v215, v248, v247
    v_add_f32 v202, 1.0, v202
    v_mul_f32 v250, v220, v246
    v_mfma_f32_32x32x16_bf16 v[128:143], v[156:159], a[100:103], v[128:143]
    s_add_u32 s50, s50, 4096
    buffer_load_dwordx4 a[48:51], v206, s[44:47], s50 offen sc1
    v_mul_f32 v251, v220, v247
    v_add_f32 v203, 1.0, v203
    v_fma_f32 v250, -v221, v247, v250
    v_mfma_f32_32x32x16_bf16 v[168:183], v[156:159], a[228:231], v[168:183]
    v_fma_f32 v251, v221, v246, v251
    v_rcp_f32 v200, v200
    v_mov_b32 v252, v250
    v_mov_b32 v253, v251
    v_rcp_f32 v201, v201
    s_waitcnt lgkmcnt(4)
    v_mfma_f32_32x32x16_bf16 v[96:111], v[160:163], a[104:107], v[96:111]
    ds_read_b64_tr_b16 v[152:153], v237 offset:57344
    ds_read_b64_tr_b16 v[154:155], v237 offset:57856
    v_permlane32_swap_b32 v250, v252
    v_permlane32_swap_b32 v251, v253
    v_rcp_f32 v202, v202
    v_mfma_f32_32x32x16_bf16 v[112:127], v[160:163], a[232:235], v[112:127]
    buffer_load_dwordx4 a[176:179], v207, s[44:47], s50 offen sc1
    ds_read_b64_tr_b16 v[156:157], v238 offset:57344
    ds_read_b64_tr_b16 v[158:159], v238 offset:57856
    v_add_f32 v250, v250, v252
    v_add_f32 v251, v251, v253
    v_mfma_f32_32x32x16_bf16 v[128:143], v[164:167], a[104:107], v[128:143]
    v_rcp_f32 v203, v203
    v_mov_b32 v252, v250
    v_mov_b32 v253, v251
    v_mul_f32 v92, v92, v200
    v_permlane16_swap_b32 v250, v252
    v_mfma_f32_32x32x16_bf16 v[168:183], v[164:167], a[232:235], v[168:183]
    v_permlane16_swap_b32 v251, v253
    v_mul_f32 v93, v93, v201
    v_add_f32 v250, v250, v252
    v_add_f32 v251, v251, v253
    v_mul_f32 v94, v94, v202
    v_fma_f32 v222, v216, v250, v222
    s_waitcnt lgkmcnt(4)
    v_mfma_f32_32x32x16_bf16 v[96:111], v[144:147], a[108:111], v[96:111]
    buffer_load_dwordx4 a[52:55], v206, s[44:47], s50 offen offset:2048 sc1
    ds_read_b64_tr_b16 v[160:161], v237 offset:59392
    ds_read_b64_tr_b16 v[162:163], v237 offset:59904
    v_fma_f32 v223, v216, v251, v223
    v_mul_f32 v95, v95, v203
    v_mfma_f32_32x32x16_bf16 v[112:127], v[144:147], a[236:239], v[112:127]
    ds_read_b64_tr_b16 v[164:165], v238 offset:59392
    ds_read_b64_tr_b16 v[166:167], v238 offset:59904
    v_fma_f32 v222, -v217, v251, v222
    v_fma_f32 v223, v217, v250, v223
    v_cvt_pk_bf16_f32 v82, v92, v93
    v_fma_f32 v0, v210, v222, v0
    v_mfma_f32_32x32x16_bf16 v[128:143], v[148:151], a[108:111], v[128:143]
    buffer_load_dwordx4 a[180:183], v207, s[44:47], s50 offen offset:2048 sc1
    v_fma_f32 v32, v210, v223, v32
    v_cvt_pk_bf16_f32 v83, v94, v95
    v_fma_f32 v0, -v211, v223, v0
    v_fma_f32 v32, v211, v222, v32
    v_mfma_f32_32x32x16_bf16 v[168:183], v[148:151], a[236:239], v[168:183]
    buffer_store_dwordx4 v[80:83], v225, s[44:47], s13 offen offset:2048 sc1
    v_fma_f32 v1, v210, v0, v1
    v_fma_f32 v33, v210, v32, v33
    v_fma_f32 v1, -v211, v32, v1
    v_fma_f32 v33, v211, v0, v33
    s_waitcnt lgkmcnt(4)
    v_mfma_f32_32x32x16_bf16 v[96:111], v[152:155], a[112:115], v[96:111]
    ds_read_b64_tr_b16 v[144:145], v237 offset:61440
    ds_read_b64_tr_b16 v[146:147], v237 offset:61952
    v_cvt_pk_bf16_f32 v184, v0, v1
    v_cvt_pk_bf16_f32 v192, -v32, -v33
    v_fma_f32 v2, v210, v1, v2
    v_fma_f32 v34, v210, v33, v34
    v_mfma_f32_32x32x16_bf16 v[112:127], v[152:155], a[240:243], v[112:127]
    s_add_u32 s50, s50, 4096
    buffer_load_dwordx4 a[56:59], v206, s[44:47], s50 offen sc1
    ds_read_b64_tr_b16 v[148:149], v238 offset:61440
    ds_read_b64_tr_b16 v[150:151], v238 offset:61952
    v_fma_f32 v2, -v211, v33, v2
    v_mfma_f32_32x32x16_bf16 v[128:143], v[156:159], a[112:115], v[128:143]
    v_fma_f32 v34, v211, v1, v34
    v_fma_f32 v3, v210, v2, v3
    v_fma_f32 v35, v210, v34, v35
    v_fma_f32 v3, -v211, v34, v3
    v_fma_f32 v35, v211, v2, v35
    v_cvt_pk_bf16_f32 v185, v2, v3
    v_mfma_f32_32x32x16_bf16 v[168:183], v[156:159], a[240:243], v[168:183]
    v_cvt_pk_bf16_f32 v193, -v34, -v35
    v_fma_f32 v4, v210, v3, v4
    v_fma_f32 v36, v210, v35, v36
    v_fma_f32 v4, -v211, v35, v4
    v_fma_f32 v36, v211, v3, v36
    v_fma_f32 v5, v210, v4, v5
    s_waitcnt lgkmcnt(4)
    v_mfma_f32_32x32x16_bf16 v[96:111], v[160:163], a[116:119], v[96:111]
    buffer_load_dwordx4 a[184:187], v207, s[44:47], s50 offen sc1
    ds_read_b64_tr_b16 v[152:153], v237 offset:63488
    ds_read_b64_tr_b16 v[154:155], v237 offset:64000
    v_fma_f32 v37, v210, v36, v37
    v_fma_f32 v5, -v211, v36, v5
    v_mfma_f32_32x32x16_bf16 v[112:127], v[160:163], a[244:247], v[112:127]
    ds_read_b64_tr_b16 v[156:157], v238 offset:63488
    ds_read_b64_tr_b16 v[158:159], v238 offset:64000
    v_fma_f32 v37, v211, v4, v37
    v_cvt_pk_bf16_f32 v186, v4, v5
    v_cvt_pk_bf16_f32 v194, -v36, -v37
    v_fma_f32 v6, v210, v5, v6
    v_mfma_f32_32x32x16_bf16 v[128:143], v[164:167], a[116:119], v[128:143]
    v_fma_f32 v38, v210, v37, v38
    v_fma_f32 v6, -v211, v37, v6
    v_fma_f32 v38, v211, v5, v38
    v_fma_f32 v7, v210, v6, v7
    v_fma_f32 v39, v210, v38, v39
    v_fma_f32 v7, -v211, v38, v7
    v_mfma_f32_32x32x16_bf16 v[168:183], v[164:167], a[244:247], v[168:183]
    buffer_load_dwordx4 a[60:63], v206, s[44:47], s50 offen offset:2048 sc1
    v_fma_f32 v39, v211, v6, v39
    v_cvt_pk_bf16_f32 v187, v6, v7
    v_cvt_pk_bf16_f32 v195, -v38, -v39
    ds_write_b128 v233, v[184:187] offset:0
    s_waitcnt lgkmcnt(5)
    v_mfma_f32_32x32x16_bf16 v[96:111], v[144:147], a[120:123], v[96:111]
    ds_write_b128 v233, v[192:195] offset:2048
    v_fma_f32 v8, v210, v7, v8
    v_fma_f32 v40, v210, v39, v40
    v_fma_f32 v8, -v211, v39, v8
    v_fma_f32 v40, v211, v7, v40
    v_fma_f32 v9, v210, v8, v9
    v_mfma_f32_32x32x16_bf16 v[112:127], v[144:147], a[248:251], v[112:127]
    buffer_load_dwordx4 a[188:191], v207, s[44:47], s50 offen offset:2048 sc1
    v_fma_f32 v41, v210, v40, v41
    v_fma_f32 v9, -v211, v40, v9
    v_fma_f32 v41, v211, v8, v41
    v_cvt_pk_bf16_f32 v188, v8, v9
    v_mfma_f32_32x32x16_bf16 v[128:143], v[148:151], a[120:123], v[128:143]
    v_cvt_pk_bf16_f32 v196, -v40, -v41
    v_fma_f32 v10, v210, v9, v10
    v_fma_f32 v42, v210, v41, v42
    v_fma_f32 v10, -v211, v41, v10
    v_fma_f32 v42, v211, v9, v42
    v_fma_f32 v11, v210, v10, v11
    v_mfma_f32_32x32x16_bf16 v[168:183], v[148:151], a[248:251], v[168:183]
    v_fma_f32 v43, v210, v42, v43
    v_fma_f32 v11, -v211, v42, v11
    v_fma_f32 v43, v211, v10, v43
    v_cvt_pk_bf16_f32 v189, v10, v11
    v_cvt_pk_bf16_f32 v197, -v42, -v43
    v_fma_f32 v12, v210, v11, v12
    s_waitcnt lgkmcnt(2)
    v_mfma_f32_32x32x16_bf16 v[96:111], v[152:155], a[124:127], v[96:111]
    s_add_u32 s50, s50, 4096
    buffer_load_dwordx4 a[64:67], v206, s[44:47], s50 offen sc1
    v_fma_f32 v44, v210, v43, v44
    v_fma_f32 v12, -v211, v43, v12
    v_fma_f32 v44, v211, v11, v44
    v_mfma_f32_32x32x16_bf16 v[112:127], v[152:155], a[252:255], v[112:127]
    v_fma_f32 v13, v210, v12, v13
    v_fma_f32 v45, v210, v44, v45
    v_fma_f32 v13, -v211, v44, v13
    v_fma_f32 v45, v211, v12, v45
    v_cvt_pk_bf16_f32 v190, v12, v13
    v_cvt_pk_bf16_f32 v198, -v44, -v45
    v_mfma_f32_32x32x16_bf16 v[128:143], v[156:159], a[124:127], v[128:143]
    v_fma_f32 v14, v210, v13, v14
    v_fma_f32 v46, v210, v45, v46
    v_fma_f32 v14, -v211, v45, v14
    v_fma_f32 v46, v211, v13, v46
    v_fma_f32 v15, v210, v14, v15
    v_fma_f32 v47, v210, v46, v47
    v_mfma_f32_32x32x16_bf16 v[168:183], v[156:159], a[252:255], v[168:183]
    buffer_load_dwordx4 a[192:195], v207, s[44:47], s50 offen sc1
    v_fma_f32 v15, -v211, v46, v15
    v_fma_f32 v47, v211, v14, v47
    v_cvt_pk_bf16_f32 v191, v14, v15
    v_cvt_pk_bf16_f32 v199, -v46, -v47
    ds_write_b128 v234, v[188:191] offset:0
    ds_write_b128 v234, v[196:199] offset:2048
    v_mul_f32 v200, 0xbfb8aa3b, v96
    s_waitcnt lgkmcnt(0)
    ds_read_b64_tr_b16 v[16:17], v235 offset:0
    v_mul_f32 v201, 0xbfb8aa3b, v97
    ds_read_b64_tr_b16 v[18:19], v236 offset:512
    ds_read_b64_tr_b16 v[20:21], v236 offset:0
    v_mul_f32 v202, 0xbfb8aa3b, v98
    ds_read_b64_tr_b16 v[22:23], v235 offset:512
    ds_read_b64_tr_b16 v[24:25], v235 offset:2048
    v_mul_f32 v203, 0xbfb8aa3b, v99
    ds_read_b64_tr_b16 v[26:27], v236 offset:2560
    ds_read_b64_tr_b16 v[28:29], v236 offset:2048
    v_exp_f32 v200, v200
    ds_read_b64_tr_b16 v[30:31], v235 offset:2560
    s_waitcnt lgkmcnt(6)
    buffer_store_dwordx4 v[16:19], v229, s[44:47], s16 offen sc1
    v_exp_f32 v201, v201
    s_waitcnt lgkmcnt(4)
    buffer_store_dwordx4 v[20:23], v229, s[44:47], s16 offen offset:1024 sc1
    s_waitcnt lgkmcnt(2)
    buffer_store_dwordx4 v[24:27], v229, s[44:47], s16 offen offset:2048 sc1
    v_exp_f32 v202, v202
    s_waitcnt lgkmcnt(0)
    buffer_store_dwordx4 v[28:31], v229, s[44:47], s16 offen offset:3072 sc1
    v_exp_f32 v203, v203
    v_mul_f32 v104, v96, v104
    buffer_load_dwordx4 a[68:71], v206, s[44:47], s50 offen offset:2048 sc1
    v_mul_f32 v105, v97, v105
    v_mul_f32 v106, v98, v106
    v_mul_f32 v107, v99, v107
    v_add_f32 v200, 1.0, v200
    v_add_f32 v201, 1.0, v201
    v_add_f32 v202, 1.0, v202
    v_add_f32 v203, 1.0, v203
    v_rcp_f32 v200, v200
    v_rcp_f32 v201, v201
    v_rcp_f32 v202, v202
    v_rcp_f32 v203, v203
    v_mul_f32 v104, v104, v200
    v_mul_f32 v105, v105, v201
    v_mul_f32 v106, v106, v202
    v_mul_f32 v107, v107, v203
    v_cvt_pk_bf16_f32 v96, v104, v105
    buffer_load_dwordx4 a[196:199], v207, s[44:47], s50 offen offset:2048 sc1
    v_cvt_pk_bf16_f32 v97, v106, v107
    v_mul_f32 v200, 0xbfb8aa3b, v100
    v_mul_f32 v201, 0xbfb8aa3b, v101
    v_mul_f32 v202, 0xbfb8aa3b, v102
    v_mul_f32 v203, 0xbfb8aa3b, v103
    v_exp_f32 v200, v200
    v_exp_f32 v201, v201
    v_exp_f32 v202, v202
    v_exp_f32 v203, v203
    v_mul_f32 v108, v100, v108
    v_mul_f32 v109, v101, v109
    v_mul_f32 v110, v102, v110
    v_mul_f32 v111, v103, v111
    v_add_f32 v200, 1.0, v200
    v_add_f32 v201, 1.0, v201
    v_add_f32 v202, 1.0, v202
    v_add_f32 v203, 1.0, v203
    v_rcp_f32 v200, v200
    v_rcp_f32 v201, v201
    v_rcp_f32 v202, v202
    v_rcp_f32 v203, v203
    v_mul_f32 v108, v108, v200
    v_mul_f32 v109, v109, v201
    v_mul_f32 v110, v110, v202
    s_add_u32 s50, s50, 4096
    buffer_load_dwordx4 a[72:75], v206, s[44:47], s50 offen sc1
    v_mul_f32 v111, v111, v203
    v_cvt_pk_bf16_f32 v98, v108, v109
    v_cvt_pk_bf16_f32 v99, v110, v111
    buffer_store_dwordx4 v[96:99], v224, s[44:47], s11 offen sc1
    v_mul_f32 v200, 0xbfb8aa3b, v112
    v_mul_f32 v201, 0xbfb8aa3b, v113
    v_mul_f32 v202, 0xbfb8aa3b, v114
    v_mul_f32 v203, 0xbfb8aa3b, v115
    v_exp_f32 v200, v200
    v_exp_f32 v201, v201
    v_exp_f32 v202, v202
    v_exp_f32 v203, v203
    v_mul_f32 v120, v112, v120
    v_mul_f32 v121, v113, v121
    v_mul_f32 v122, v114, v122
    v_mul_f32 v123, v115, v123
    v_add_f32 v200, 1.0, v200
    v_add_f32 v201, 1.0, v201
    v_add_f32 v202, 1.0, v202
    v_add_f32 v203, 1.0, v203
    v_rcp_f32 v200, v200
    v_rcp_f32 v201, v201
    v_rcp_f32 v202, v202
    v_rcp_f32 v203, v203
    buffer_load_dwordx4 a[200:203], v207, s[44:47], s50 offen sc1
    v_mul_f32 v120, v120, v200
    v_mul_f32 v121, v121, v201
    v_mul_f32 v122, v122, v202
    v_mul_f32 v123, v123, v203
    v_cvt_pk_bf16_f32 v112, v120, v121
    v_cvt_pk_bf16_f32 v113, v122, v123
    v_mul_f32 v200, 0xbfb8aa3b, v116
    v_mul_f32 v201, 0xbfb8aa3b, v117
    v_mul_f32 v202, 0xbfb8aa3b, v118
    v_mul_f32 v203, 0xbfb8aa3b, v119
    v_exp_f32 v200, v200
    v_exp_f32 v201, v201
    v_exp_f32 v202, v202
    v_exp_f32 v203, v203
    v_mul_f32 v124, v116, v124
    v_mul_f32 v125, v117, v125
    v_mul_f32 v126, v118, v126
    v_mul_f32 v127, v119, v127
    v_add_f32 v200, 1.0, v200
    v_add_f32 v201, 1.0, v201
    v_add_f32 v202, 1.0, v202
    v_add_f32 v203, 1.0, v203
    v_rcp_f32 v200, v200
    v_rcp_f32 v201, v201
    buffer_load_dwordx4 a[76:79], v206, s[44:47], s50 offen offset:2048 sc1
    v_rcp_f32 v202, v202
    v_rcp_f32 v203, v203
    v_mul_f32 v124, v124, v200
    v_mul_f32 v125, v125, v201
    v_mul_f32 v126, v126, v202
    v_mul_f32 v127, v127, v203
    v_cvt_pk_bf16_f32 v114, v124, v125
    v_cvt_pk_bf16_f32 v115, v126, v127
    buffer_store_dwordx4 v[112:115], v225, s[44:47], s11 offen sc1
    v_mul_f32 v200, 0xbfb8aa3b, v128
    v_mul_f32 v201, 0xbfb8aa3b, v129
    v_mul_f32 v202, 0xbfb8aa3b, v130
    v_mul_f32 v203, 0xbfb8aa3b, v131
    v_exp_f32 v200, v200
    v_exp_f32 v201, v201
    v_exp_f32 v202, v202
    buffer_load_dwordx4 a[204:207], v207, s[44:47], s50 offen offset:2048 sc1
    v_exp_f32 v203, v203
    v_mul_f32 v136, v128, v136
    v_mul_f32 v137, v129, v137
    v_mul_f32 v138, v130, v138
    v_mul_f32 v139, v131, v139
    v_add_f32 v200, 1.0, v200
    v_add_f32 v201, 1.0, v201
    v_add_f32 v202, 1.0, v202
    v_add_f32 v203, 1.0, v203
    v_rcp_f32 v200, v200
    v_rcp_f32 v201, v201
    v_rcp_f32 v202, v202
    v_rcp_f32 v203, v203
    v_mul_f32 v136, v136, v200
    v_mul_f32 v137, v137, v201
    v_mul_f32 v138, v138, v202
    v_mul_f32 v139, v139, v203
    v_cvt_pk_bf16_f32 v128, v136, v137
    v_cvt_pk_bf16_f32 v129, v138, v139
    v_mul_f32 v200, 0xbfb8aa3b, v132
    v_mul_f32 v201, 0xbfb8aa3b, v133
    v_mul_f32 v202, 0xbfb8aa3b, v134
    v_mul_f32 v203, 0xbfb8aa3b, v135
    v_exp_f32 v200, v200
    s_add_u32 s50, s50, 4096
    buffer_load_dwordx4 a[80:83], v206, s[44:47], s50 offen sc1
    v_exp_f32 v201, v201
    v_exp_f32 v202, v202
    v_exp_f32 v203, v203
    v_mul_f32 v140, v132, v140
    v_mul_f32 v141, v133, v141
    v_mul_f32 v142, v134, v142
    v_mul_f32 v143, v135, v143
    v_add_f32 v200, 1.0, v200
    v_add_f32 v201, 1.0, v201
    v_add_f32 v202, 1.0, v202
    v_add_f32 v203, 1.0, v203
    v_rcp_f32 v200, v200
    v_rcp_f32 v201, v201
    v_rcp_f32 v202, v202
    v_rcp_f32 v203, v203
    v_mul_f32 v140, v140, v200
    v_mul_f32 v141, v141, v201
    v_mul_f32 v142, v142, v202
    v_mul_f32 v143, v143, v203
    v_cvt_pk_bf16_f32 v130, v140, v141
    v_cvt_pk_bf16_f32 v131, v142, v143
    buffer_store_dwordx4 v[128:131], v224, s[44:47], s11 offen offset:2048 sc1
    v_mul_f32 v200, 0xbfb8aa3b, v168
    v_mul_f32 v201, 0xbfb8aa3b, v169
    buffer_load_dwordx4 a[208:211], v207, s[44:47], s50 offen sc1
    v_mul_f32 v202, 0xbfb8aa3b, v170
    v_mul_f32 v203, 0xbfb8aa3b, v171
    v_exp_f32 v200, v200
    v_exp_f32 v201, v201
    v_exp_f32 v202, v202
    v_exp_f32 v203, v203
    v_mul_f32 v176, v168, v176
    v_mul_f32 v177, v169, v177
    v_mul_f32 v178, v170, v178
    v_mul_f32 v179, v171, v179
    v_add_f32 v200, 1.0, v200
    v_add_f32 v201, 1.0, v201
    v_add_f32 v202, 1.0, v202
    v_add_f32 v203, 1.0, v203
    v_rcp_f32 v200, v200
    v_rcp_f32 v201, v201
    v_rcp_f32 v202, v202
    v_rcp_f32 v203, v203
    v_mul_f32 v176, v176, v200
    v_mul_f32 v177, v177, v201
    v_mul_f32 v178, v178, v202
    v_mul_f32 v179, v179, v203
    v_cvt_pk_bf16_f32 v168, v176, v177
    v_cvt_pk_bf16_f32 v169, v178, v179
    buffer_load_dwordx4 a[84:87], v206, s[44:47], s50 offen offset:2048 sc1
    v_mul_f32 v200, 0xbfb8aa3b, v172
    v_mul_f32 v201, 0xbfb8aa3b, v173
    v_mul_f32 v202, 0xbfb8aa3b, v174
    v_mul_f32 v203, 0xbfb8aa3b, v175
    v_exp_f32 v200, v200
    v_exp_f32 v201, v201
    v_exp_f32 v202, v202
    v_exp_f32 v203, v203
    v_mul_f32 v180, v172, v180
    v_mul_f32 v181, v173, v181
    v_mul_f32 v182, v174, v182
    v_mul_f32 v183, v175, v183
    v_add_f32 v200, 1.0, v200
    v_add_f32 v201, 1.0, v201
    v_add_f32 v202, 1.0, v202
    v_add_f32 v203, 1.0, v203
    buffer_load_dwordx4 a[212:215], v207, s[44:47], s50 offen offset:2048 sc1
    v_rcp_f32 v200, v200
    v_rcp_f32 v201, v201
    v_rcp_f32 v202, v202
    v_rcp_f32 v203, v203
    v_mul_f32 v180, v180, v200
    v_mul_f32 v181, v181, v201
    v_mul_f32 v182, v182, v202
    v_mul_f32 v183, v183, v203
    v_cvt_pk_bf16_f32 v170, v180, v181
    v_cvt_pk_bf16_f32 v171, v182, v183
    buffer_store_dwordx4 v[168:171], v225, s[44:47], s11 offen offset:2048 sc1
    s_lshl_b32 s20, s67, 4
    s_add_u32 s20, s20, s68
    s_lshl_b32 s20, s20, 7
    s_lshl_b32 s21, s64, 3
    s_add_u32 s20, s20, s21
    s_add_u32 s20, s20, 14745600
    v_mov_b32 v250, s4
    v_mov_b32 v251, s5
    v_lshl_add_u32 v252, v209, 24, s20
    s_waitcnt vmcnt(0)
    buffer_store_dwordx2 v[250:251], v252, s[44:47], 0 offen sc1
    s_mul_i32 s70, s48, 360448
    s_lshl_b32 s71, s65, 10
    s_add_u32 s70, s70, s71
    s_add_u32 s50, s50, 4096
    buffer_load_dwordx4 a[88:91], v206, s[44:47], s50 offen sc1
    v_add_u32 v210, s70, v229
    v_xor_b32 v211, 0x400, v210
    v_bfe_u32 v226, v209, 1, 4
    buffer_load_dwordx4 a[216:219], v207, s[44:47], s50 offen sc1
    v_and_b32 v227, 1, v209
    v_lshlrev_b32 v227, 4, v227
    v_lshl_add_u32 v226, v226, 7, v227
    buffer_load_dwordx4 a[92:95], v206, s[44:47], s50 offen offset:2048 sc1
    s_lshr_b32 s70, s48, 1
    s_lshl_b32 s70, s70, 11
    s_add_u32 s70, s70, 14745600
    buffer_load_dwordx4 a[220:223], v207, s[44:47], s50 offen offset:2048 sc1
    v_add_u32 v221, s70, v226
    s_mov_b32 s36, s76
    s_mov_b32 s37, s77
    s_add_u32 s50, s50, 4096
    buffer_load_dwordx4 a[96:99], v206, s[44:47], s50 offen sc1
    s_mov_b32 s38, 4194304
    s_mov_b32 s39, 0x20000
    s_mov_b32 s40, s78
    buffer_load_dwordx4 a[224:227], v207, s[44:47], s50 offen sc1
    s_mov_b32 s41, s79
    s_mov_b32 s42, 1024
    s_mov_b32 s43, 0x20000
    buffer_load_dwordx4 a[100:103], v206, s[44:47], s50 offen offset:2048 sc1
    s_lshl_b32 s70, s48, 6
    s_lshl_b32 s71, s65, 5
    s_add_u32 s70, s70, s71
    buffer_load_dwordx4 a[228:231], v207, s[44:47], s50 offen offset:2048 sc1
    v_lshrrev_b32 v226, 5, v209
    v_lshl_add_u32 v226, v226, 2, s70
    s_lshl_b32 s70, s49, 6
    s_add_u32 s50, s50, 4096
    buffer_load_dwordx4 a[104:107], v206, s[44:47], s50 offen sc1
    s_lshl_b32 s71, s66, 5
    s_add_u32 s70, s70, s71
    v_and_b32 v227, 31, v209
    buffer_load_dwordx4 a[232:235], v207, s[44:47], s50 offen sc1
    v_add_lshl_u32 v219, v227, s70, 1
    v_lshl_add_u32 v216, v226, 10, v219
    v_lshlrev_b32 v217, 1, v216
    buffer_load_dwordx4 a[108:111], v206, s[44:47], s50 offen offset:2048 sc1
    v_lshlrev_b32 v218, 2, v226
    v_add_u32 v218, 14417920, v218
    v_mov_b32 v232, 0
    buffer_load_dwordx4 a[236:239], v207, s[44:47], s50 offen offset:2048 sc1
    v_mov_b32 v233, 0
    v_mov_b32 v234, 0
    v_mov_b32 v235, 0
    s_lshl_b32 s50, s64, 15
    buffer_load_dwordx4 a[112:115], v206, s[44:47], s50 offen sc1
    v_mov_b32 v236, 0
    v_mov_b32 v237, 0
    v_mov_b32 v238, 0
    buffer_load_dwordx4 a[240:243], v207, s[44:47], s50 offen sc1
    v_mov_b32 v239, 0
    v_mov_b32 v240, 0
    v_mov_b32 v241, 0
    buffer_load_dwordx4 a[116:119], v206, s[44:47], s50 offen offset:2048 sc1
    v_mov_b32 v242, 0
    v_mov_b32 v243, 0
    v_mov_b32 v244, 0
    buffer_load_dwordx4 a[244:247], v207, s[44:47], s50 offen offset:2048 sc1
    v_mov_b32 v245, 0
    v_mov_b32 v246, 0
    v_mov_b32 v247, 0
    s_add_u32 s50, s50, 4096
    buffer_load_dwordx4 a[120:123], v206, s[44:47], s50 offen sc1
    v_mov_b32 v220, 0
    s_mov_b32 s7, 8192
    s_mov_b32 s8, 16384
    buffer_load_dwordx4 a[248:251], v207, s[44:47], s50 offen sc1
    s_mov_b32 s9, 24576
    s_xor_b32 s70, s64, 1
    s_mul_i32 s70, s70, 12288
    buffer_load_dwordx4 a[124:127], v206, s[44:47], s50 offen offset:2048 sc1
    s_add_u32 s70, s70, 0
    v_add_u32 v212, s70, v229
    s_xor_b32 s70, s64, 2
    buffer_load_dwordx4 a[252:255], v207, s[44:47], s50 offen offset:2048 sc1
    s_mul_i32 s70, s70, 12288
    s_add_u32 s70, s70, 4096
    v_add_u32 v213, s70, v229
    s_xor_b32 s70, s64, 3
    s_mul_i32 s70, s70, 12288
    s_add_u32 s70, s70, 8192
    v_add_u32 v214, s70, v229
    s_mul_i32 s70, s64, 12288
    v_add_u32 v215, s70, v229
    buffer_load_short_d16_hi v232, v216, s[32:35], 0 offen
    buffer_load_short_d16_hi v233, v216, s[32:35], 0 offen offset:1024
    buffer_load_short_d16_hi v234, v216, s[32:35], 0 offen offset:2048
    buffer_load_short_d16_hi v235, v216, s[32:35], 0 offen offset:3072
    buffer_load_short_d16_hi v236, v216, s[32:35], s7 offen
    buffer_load_short_d16_hi v237, v216, s[32:35], s7 offen offset:1024
    buffer_load_short_d16_hi v238, v216, s[32:35], s7 offen offset:2048
    buffer_load_short_d16_hi v239, v216, s[32:35], s7 offen offset:3072
    buffer_load_short_d16_hi v240, v216, s[32:35], s8 offen
    buffer_load_short_d16_hi v241, v216, s[32:35], s8 offen offset:1024
    buffer_load_short_d16_hi v242, v216, s[32:35], s8 offen offset:2048
    buffer_load_short_d16_hi v243, v216, s[32:35], s8 offen offset:3072
    buffer_load_short_d16_hi v244, v216, s[32:35], s9 offen
    buffer_load_short_d16_hi v245, v216, s[32:35], s9 offen offset:1024
    buffer_load_short_d16_hi v246, v216, s[32:35], s9 offen offset:2048
    buffer_load_short_d16_hi v247, v216, s[32:35], s9 offen offset:3072
    buffer_load_short_d16_hi v220, v219, s[40:43], 0 offen
    buffer_load_dwordx4 v[222:225], v221, s[44:47], 0 offen sc1
    s_waitcnt vmcnt(0)
    s_mov_b32 s3, 0
fused_kernel_fa_chk:
    v_cmp_eq_u64 s[20:21], s[4:5], v[222:223]
    v_cmp_eq_u64 s[22:23], s[4:5], v[224:225]
    s_nop 1
    s_and_b64 s[20:21], s[20:21], s[22:23]
    s_cmp_eq_u64 s[20:21], -1
    s_cbranch_scc1 fused_kernel_fa_ok
fused_kernel_fa_retry:
    s_add_u32 s3, s3, 1
    s_cmp_gt_u32 s3, 0x40000
    s_cbranch_scc1 fused_kernel_fa_ok
    s_sleep 4
    buffer_load_dwordx4 v[222:225], v221, s[44:47], 0 offen sc1
    s_waitcnt vmcnt(0)
    s_branch fused_kernel_fa_chk
fused_kernel_fa_ok:
    s_mul_i32 s51, s64, 57344
    s_add_u32 s51, s51, 131072
    buffer_load_dwordx4 v[128:131], v210, s[44:47], s51 offen sc1
    buffer_load_dwordx4 v[132:135], v211, s[44:47], s51 offen sc1
    buffer_load_dwordx4 v[136:139], v210, s[44:47], s51 offen offset:2048 sc1
    buffer_load_dwordx4 v[140:143], v211, s[44:47], s51 offen offset:2048 sc1
    s_add_u32 s51, s51, 4096
    buffer_load_dwordx4 v[144:147], v210, s[44:47], s51 offen sc1
    buffer_load_dwordx4 v[148:151], v211, s[44:47], s51 offen sc1
    buffer_load_dwordx4 v[152:155], v210, s[44:47], s51 offen offset:2048 sc1
    buffer_load_dwordx4 v[156:159], v211, s[44:47], s51 offen offset:2048 sc1
    s_add_u32 s51, s51, 4096
    buffer_load_dwordx4 v[160:163], v210, s[44:47], s51 offen sc1
    buffer_load_dwordx4 v[164:167], v211, s[44:47], s51 offen sc1
    s_waitcnt vmcnt(9)
    v_mfma_f32_32x32x16_bf16 v[64:79], v[128:131], a[0:3], 0
    v_mfma_f32_32x32x16_bf16 v[80:95], v[128:131], a[128:131], 0
    buffer_load_dwordx4 v[128:131], v210, s[44:47], s51 offen offset:2048 sc1
    s_waitcnt vmcnt(9)
    v_mfma_f32_32x32x16_bf16 v[96:111], v[132:135], a[0:3], 0
    s_add_u32 s50, s50, 4096
    buffer_load_dwordx4 a[0:3], v206, s[44:47], s50 offen sc1
    v_mfma_f32_32x32x16_bf16 v[112:127], v[132:135], a[128:131], 0
    buffer_load_dwordx4 v[132:135], v211, s[44:47], s51 offen offset:2048 sc1
    buffer_load_dwordx4 a[128:131], v207, s[44:47], s50 offen sc1
    s_waitcnt vmcnt(11)
    v_mfma_f32_32x32x16_bf16 v[64:79], v[136:139], a[4:7], v[64:79]
    v_mfma_f32_32x32x16_bf16 v[80:95], v[136:139], a[132:135], v[80:95]
    s_add_u32 s51, s51, 4096
    buffer_load_dwordx4 v[136:139], v210, s[44:47], s51 offen sc1
    s_waitcnt vmcnt(11)
    v_mfma_f32_32x32x16_bf16 v[96:111], v[140:143], a[4:7], v[96:111]
    buffer_load_dwordx4 a[4:7], v206, s[44:47], s50 offen offset:2048 sc1
    v_mfma_f32_32x32x16_bf16 v[112:127], v[140:143], a[132:135], v[112:127]
    buffer_load_dwordx4 v[140:143], v211, s[44:47], s51 offen sc1
    buffer_load_dwordx4 a[132:135], v207, s[44:47], s50 offen offset:2048 sc1
    s_waitcnt vmcnt(13)
    v_mfma_f32_32x32x16_bf16 v[64:79], v[144:147], a[8:11], v[64:79]
    v_mfma_f32_32x32x16_bf16 v[80:95], v[144:147], a[136:139], v[80:95]
    buffer_load_dwordx4 v[144:147], v210, s[44:47], s51 offen offset:2048 sc1
    s_waitcnt vmcnt(13)
    v_mfma_f32_32x32x16_bf16 v[96:111], v[148:151], a[8:11], v[96:111]
    s_add_u32 s50, s50, 4096
    buffer_load_dwordx4 a[8:11], v206, s[44:47], s50 offen sc1
    v_mfma_f32_32x32x16_bf16 v[112:127], v[148:151], a[136:139], v[112:127]
    buffer_load_dwordx4 v[148:151], v211, s[44:47], s51 offen offset:2048 sc1
    buffer_load_dwordx4 a[136:139], v207, s[44:47], s50 offen sc1
    s_waitcnt vmcnt(15)
    v_mfma_f32_32x32x16_bf16 v[64:79], v[152:155], a[12:15], v[64:79]
    v_mfma_f32_32x32x16_bf16 v[80:95], v[152:155], a[140:143], v[80:95]
    s_add_u32 s51, s51, 4096
    buffer_load_dwordx4 v[152:155], v210, s[44:47], s51 offen sc1
    s_waitcnt vmcnt(15)
    v_mfma_f32_32x32x16_bf16 v[96:111], v[156:159], a[12:15], v[96:111]
    buffer_load_dwordx4 a[12:15], v206, s[44:47], s50 offen offset:2048 sc1
    v_mfma_f32_32x32x16_bf16 v[112:127], v[156:159], a[140:143], v[112:127]
    buffer_load_dwordx4 v[156:159], v211, s[44:47], s51 offen sc1
    buffer_load_dwordx4 a[140:143], v207, s[44:47], s50 offen offset:2048 sc1
    s_waitcnt vmcnt(17)
    v_mfma_f32_32x32x16_bf16 v[64:79], v[160:163], a[16:19], v[64:79]
    v_mfma_f32_32x32x16_bf16 v[80:95], v[160:163], a[144:147], v[80:95]
    buffer_load_dwordx4 v[160:163], v210, s[44:47], s51 offen offset:2048 sc1
    s_waitcnt vmcnt(17)
    v_mfma_f32_32x32x16_bf16 v[96:111], v[164:167], a[16:19], v[96:111]
    s_add_u32 s50, s50, 4096
    buffer_load_dwordx4 a[16:19], v206, s[44:47], s50 offen sc1
    v_mfma_f32_32x32x16_bf16 v[112:127], v[164:167], a[144:147], v[112:127]
    buffer_load_dwordx4 v[164:167], v211, s[44:47], s51 offen offset:2048 sc1
    buffer_load_dwordx4 a[144:147], v207, s[44:47], s50 offen sc1
    s_waitcnt vmcnt(19)
    v_mfma_f32_32x32x16_bf16 v[64:79], v[128:131], a[20:23], v[64:79]
    v_mfma_f32_32x32x16_bf16 v[80:95], v[128:131], a[148:151], v[80:95]
    s_add_u32 s51, s51, 4096
    buffer_load_dwordx4 v[128:131], v210, s[44:47], s51 offen sc1
    s_waitcnt vmcnt(18)
    v_mfma_f32_32x32x16_bf16 v[96:111], v[132:135], a[20:23], v[96:111]
    buffer_load_dwordx4 a[20:23], v206, s[44:47], s50 offen offset:2048 sc1
    v_mfma_f32_32x32x16_bf16 v[112:127], v[132:135], a[148:151], v[112:127]
    buffer_load_dwordx4 v[132:135], v211, s[44:47], s51 offen sc1
    buffer_load_dwordx4 a[148:151], v207, s[44:47], s50 offen offset:2048 sc1
    s_waitcnt vmcnt(19)
    v_mfma_f32_32x32x16_bf16 v[64:79], v[136:139], a[24:27], v[64:79]
    v_mfma_f32_32x32x16_bf16 v[80:95], v[136:139], a[152:155], v[80:95]
    buffer_load_dwordx4 v[136:139], v210, s[44:47], s51 offen offset:2048 sc1
    s_waitcnt vmcnt(18)
    v_mfma_f32_32x32x16_bf16 v[96:111], v[140:143], a[24:27], v[96:111]
    s_add_u32 s50, s50, 4096
    buffer_load_dwordx4 a[24:27], v206, s[44:47], s50 offen sc1
    v_mfma_f32_32x32x16_bf16 v[112:127], v[140:143], a[152:155], v[112:127]
    buffer_load_dwordx4 v[140:143], v211, s[44:47], s51 offen offset:2048 sc1
    buffer_load_dwordx4 a[152:155], v207, s[44:47], s50 offen sc1
    s_waitcnt vmcnt(19)
    v_mfma_f32_32x32x16_bf16 v[64:79], v[144:147], a[28:31], v[64:79]
    v_mfma_f32_32x32x16_bf16 v[80:95], v[144:147], a[156:159], v[80:95]
    s_add_u32 s51, s51, 4096
    buffer_load_dwordx4 v[144:147], v210, s[44:47], s51 offen sc1
    s_waitcnt vmcnt(18)
    v_mfma_f32_32x32x16_bf16 v[96:111], v[148:151], a[28:31], v[96:111]
    buffer_load_dwordx4 a[28:31], v206, s[44:47], s50 offen offset:2048 sc1
    v_mfma_f32_32x32x16_bf16 v[112:127], v[148:151], a[156:159], v[112:127]
    buffer_load_dwordx4 v[148:151], v211, s[44:47], s51 offen sc1
    buffer_load_dwordx4 a[156:159], v207, s[44:47], s50 offen offset:2048 sc1
    s_waitcnt vmcnt(19)
    v_mfma_f32_32x32x16_bf16 v[64:79], v[152:155], a[32:35], v[64:79]
    v_mfma_f32_32x32x16_bf16 v[80:95], v[152:155], a[160:163], v[80:95]
    buffer_load_dwordx4 v[152:155], v210, s[44:47], s51 offen offset:2048 sc1
    s_waitcnt vmcnt(18)
    v_mfma_f32_32x32x16_bf16 v[96:111], v[156:159], a[32:35], v[96:111]
    s_add_u32 s50, s50, 4096
    buffer_load_dwordx4 a[32:35], v206, s[44:47], s50 offen sc1
    v_mfma_f32_32x32x16_bf16 v[112:127], v[156:159], a[160:163], v[112:127]
    buffer_load_dwordx4 v[156:159], v211, s[44:47], s51 offen offset:2048 sc1
    buffer_load_dwordx4 a[160:163], v207, s[44:47], s50 offen sc1
    s_waitcnt vmcnt(19)
    v_mfma_f32_32x32x16_bf16 v[64:79], v[160:163], a[36:39], v[64:79]
    v_mfma_f32_32x32x16_bf16 v[80:95], v[160:163], a[164:167], v[80:95]
    s_add_u32 s51, s51, 4096
    buffer_load_dwordx4 v[160:163], v210, s[44:47], s51 offen sc1
    s_waitcnt vmcnt(18)
    v_mfma_f32_32x32x16_bf16 v[96:111], v[164:167], a[36:39], v[96:111]
    buffer_load_dwordx4 a[36:39], v206, s[44:47], s50 offen offset:2048 sc1
    v_mfma_f32_32x32x16_bf16 v[112:127], v[164:167], a[164:167], v[112:127]
    buffer_load_dwordx4 v[164:167], v211, s[44:47], s51 offen sc1
    buffer_load_dwordx4 a[164:167], v207, s[44:47], s50 offen offset:2048 sc1
    s_waitcnt vmcnt(19)
    v_mfma_f32_32x32x16_bf16 v[64:79], v[128:131], a[40:43], v[64:79]
    v_mfma_f32_32x32x16_bf16 v[80:95], v[128:131], a[168:171], v[80:95]
    buffer_load_dwordx4 v[128:131], v210, s[44:47], s51 offen offset:2048 sc1
    s_waitcnt vmcnt(18)
    v_mfma_f32_32x32x16_bf16 v[96:111], v[132:135], a[40:43], v[96:111]
    s_add_u32 s50, s50, 4096
    buffer_load_dwordx4 a[40:43], v206, s[44:47], s50 offen sc1
    v_mfma_f32_32x32x16_bf16 v[112:127], v[132:135], a[168:171], v[112:127]
    buffer_load_dwordx4 v[132:135], v211, s[44:47], s51 offen offset:2048 sc1
    buffer_load_dwordx4 a[168:171], v207, s[44:47], s50 offen sc1
    s_barrier
    s_waitcnt vmcnt(19)
    v_mfma_f32_32x32x16_bf16 v[64:79], v[136:139], a[44:47], v[64:79]
    v_mfma_f32_32x32x16_bf16 v[80:95], v[136:139], a[172:175], v[80:95]
    s_add_u32 s51, s51, 4096
    buffer_load_dwordx4 v[136:139], v210, s[44:47], s51 offen sc1
    s_waitcnt vmcnt(18)
    v_mfma_f32_32x32x16_bf16 v[96:111], v[140:143], a[44:47], v[96:111]
    buffer_load_dwordx4 a[44:47], v206, s[44:47], s50 offen offset:2048 sc1
    v_mfma_f32_32x32x16_bf16 v[112:127], v[140:143], a[172:175], v[112:127]
    buffer_load_dwordx4 v[140:143], v211, s[44:47], s51 offen sc1
    buffer_load_dwordx4 a[172:175], v207, s[44:47], s50 offen offset:2048 sc1
    s_waitcnt vmcnt(19)
    v_mfma_f32_32x32x16_bf16 v[64:79], v[144:147], a[48:51], v[64:79]
    v_mfma_f32_32x32x16_bf16 v[80:95], v[144:147], a[176:179], v[80:95]
    buffer_load_dwordx4 v[144:147], v210, s[44:47], s51 offen offset:2048 sc1
    s_waitcnt vmcnt(18)
    v_mfma_f32_32x32x16_bf16 v[96:111], v[148:151], a[48:51], v[96:111]
    v_mfma_f32_32x32x16_bf16 v[112:127], v[148:151], a[176:179], v[112:127]
    buffer_load_dwordx4 v[148:151], v211, s[44:47], s51 offen offset:2048 sc1
    buffer_load_dwordx4 v[184:187], v218, s[44:47], 0 offen offset:0 sc1
    s_waitcnt vmcnt(18)
    v_mfma_f32_32x32x16_bf16 v[64:79], v[152:155], a[52:55], v[64:79]
    v_mfma_f32_32x32x16_bf16 v[80:95], v[152:155], a[180:183], v[80:95]
    s_add_u32 s51, s51, 4096
    buffer_load_dwordx4 v[152:155], v210, s[44:47], s51 offen sc1
    s_waitcnt vmcnt(17)
    v_mfma_f32_32x32x16_bf16 v[96:111], v[156:159], a[52:55], v[96:111]
    v_mfma_f32_32x32x16_bf16 v[112:127], v[156:159], a[180:183], v[112:127]
    buffer_load_dwordx4 v[156:159], v211, s[44:47], s51 offen sc1
    buffer_load_dwordx4 v[188:191], v218, s[44:47], 0 offen offset:32 sc1
    s_waitcnt vmcnt(17)
    v_mfma_f32_32x32x16_bf16 v[64:79], v[160:163], a[56:59], v[64:79]
    v_mfma_f32_32x32x16_bf16 v[80:95], v[160:163], a[184:187], v[80:95]
    buffer_load_dwordx4 v[160:163], v210, s[44:47], s51 offen offset:2048 sc1
    s_waitcnt vmcnt(16)
    v_mfma_f32_32x32x16_bf16 v[96:111], v[164:167], a[56:59], v[96:111]
    v_mfma_f32_32x32x16_bf16 v[112:127], v[164:167], a[184:187], v[112:127]
    buffer_load_dwordx4 v[164:167], v211, s[44:47], s51 offen offset:2048 sc1
    buffer_load_dwordx4 v[192:195], v218, s[44:47], 0 offen offset:64 sc1
    s_waitcnt vmcnt(16)
    v_mfma_f32_32x32x16_bf16 v[64:79], v[128:131], a[60:63], v[64:79]
    v_mfma_f32_32x32x16_bf16 v[80:95], v[128:131], a[188:191], v[80:95]
    s_add_u32 s51, s51, 4096
    buffer_load_dwordx4 v[128:131], v210, s[44:47], s51 offen sc1
    s_waitcnt vmcnt(15)
    v_mfma_f32_32x32x16_bf16 v[96:111], v[132:135], a[60:63], v[96:111]
    v_mfma_f32_32x32x16_bf16 v[112:127], v[132:135], a[188:191], v[112:127]
    buffer_load_dwordx4 v[132:135], v211, s[44:47], s51 offen sc1
    buffer_load_dwordx4 v[196:199], v218, s[44:47], 0 offen offset:96 sc1
    s_waitcnt vmcnt(15)
    v_mfma_f32_32x32x16_bf16 v[64:79], v[136:139], a[64:67], v[64:79]
    v_mfma_f32_32x32x16_bf16 v[80:95], v[136:139], a[192:195], v[80:95]
    buffer_load_dwordx4 v[136:139], v210, s[44:47], s51 offen offset:2048 sc1
    s_waitcnt vmcnt(14)
    v_mfma_f32_32x32x16_bf16 v[96:111], v[140:143], a[64:67], v[96:111]
    v_mfma_f32_32x32x16_bf16 v[112:127], v[140:143], a[192:195], v[112:127]
    buffer_load_dwordx4 v[140:143], v211, s[44:47], s51 offen offset:2048 sc1
    s_waitcnt vmcnt(13)
    v_mfma_f32_32x32x16_bf16 v[64:79], v[144:147], a[68:71], v[64:79]
    v_mfma_f32_32x32x16_bf16 v[80:95], v[144:147], a[196:199], v[80:95]
    s_add_u32 s51, s51, 4096
    buffer_load_dwordx4 v[144:147], v210, s[44:47], s51 offen sc1
    s_waitcnt vmcnt(13)
    v_mfma_f32_32x32x16_bf16 v[96:111], v[148:151], a[68:71], v[96:111]
    v_mfma_f32_32x32x16_bf16 v[112:127], v[148:151], a[196:199], v[112:127]
    buffer_load_dwordx4 v[148:151], v211, s[44:47], s51 offen sc1
    s_waitcnt vmcnt(12)
    v_mfma_f32_32x32x16_bf16 v[64:79], v[152:155], a[72:75], v[64:79]
    v_mfma_f32_32x32x16_bf16 v[80:95], v[152:155], a[200:203], v[80:95]
    buffer_load_dwordx4 v[152:155], v210, s[44:47], s51 offen offset:2048 sc1
    s_waitcnt vmcnt(12)
    v_mfma_f32_32x32x16_bf16 v[96:111], v[156:159], a[72:75], v[96:111]
    v_mfma_f32_32x32x16_bf16 v[112:127], v[156:159], a[200:203], v[112:127]
    buffer_load_dwordx4 v[156:159], v211, s[44:47], s51 offen offset:2048 sc1
    s_waitcnt vmcnt(11)
    v_mfma_f32_32x32x16_bf16 v[64:79], v[160:163], a[76:79], v[64:79]
    v_mfma_f32_32x32x16_bf16 v[80:95], v[160:163], a[204:207], v[80:95]
    s_add_u32 s51, s51, 4096
    buffer_load_dwordx4 v[160:163], v210, s[44:47], s51 offen sc1
    s_waitcnt vmcnt(11)
    v_mfma_f32_32x32x16_bf16 v[96:111], v[164:167], a[76:79], v[96:111]
    v_mfma_f32_32x32x16_bf16 v[112:127], v[164:167], a[204:207], v[112:127]
    buffer_load_dwordx4 v[164:167], v211, s[44:47], s51 offen sc1
    s_waitcnt vmcnt(10)
    v_mfma_f32_32x32x16_bf16 v[64:79], v[128:131], a[80:83], v[64:79]
    v_mfma_f32_32x32x16_bf16 v[80:95], v[128:131], a[208:211], v[80:95]
    buffer_load_dwordx4 v[128:131], v210, s[44:47], s51 offen offset:2048 sc1
    s_waitcnt vmcnt(10)
    v_mfma_f32_32x32x16_bf16 v[96:111], v[132:135], a[80:83], v[96:111]
    v_mfma_f32_32x32x16_bf16 v[112:127], v[132:135], a[208:211], v[112:127]
    buffer_load_dwordx4 v[132:135], v211, s[44:47], s51 offen offset:2048 sc1
    s_waitcnt vmcnt(9)
    v_mfma_f32_32x32x16_bf16 v[64:79], v[136:139], a[84:87], v[64:79]
    v_mfma_f32_32x32x16_bf16 v[80:95], v[136:139], a[212:215], v[80:95]
    s_add_u32 s51, s51, 4096
    buffer_load_dwordx4 v[136:139], v210, s[44:47], s51 offen sc1
    s_waitcnt vmcnt(9)
    v_mfma_f32_32x32x16_bf16 v[96:111], v[140:143], a[84:87], v[96:111]
    v_mfma_f32_32x32x16_bf16 v[112:127], v[140:143], a[212:215], v[112:127]
    buffer_load_dwordx4 v[140:143], v211, s[44:47], s51 offen sc1
    s_waitcnt vmcnt(9)
    v_mfma_f32_32x32x16_bf16 v[64:79], v[144:147], a[88:91], v[64:79]
    v_mfma_f32_32x32x16_bf16 v[80:95], v[144:147], a[216:219], v[80:95]
    buffer_load_dwordx4 v[144:147], v210, s[44:47], s51 offen offset:2048 sc1
    s_waitcnt vmcnt(9)
    v_mfma_f32_32x32x16_bf16 v[96:111], v[148:151], a[88:91], v[96:111]
    v_mfma_f32_32x32x16_bf16 v[112:127], v[148:151], a[216:219], v[112:127]
    buffer_load_dwordx4 v[148:151], v211, s[44:47], s51 offen offset:2048 sc1
    s_waitcnt vmcnt(9)
    v_mfma_f32_32x32x16_bf16 v[64:79], v[152:155], a[92:95], v[64:79]
    v_mfma_f32_32x32x16_bf16 v[80:95], v[152:155], a[220:223], v[80:95]
    s_lshl_b32 s51, s64, 15
    buffer_load_dwordx4 v[152:155], v210, s[44:47], s51 offen sc1
    s_waitcnt vmcnt(9)
    v_mfma_f32_32x32x16_bf16 v[96:111], v[156:159], a[92:95], v[96:111]
    v_mfma_f32_32x32x16_bf16 v[112:127], v[156:159], a[220:223], v[112:127]
    buffer_load_dwordx4 v[156:159], v211, s[44:47], s51 offen sc1
    s_waitcnt vmcnt(9)
    v_mfma_f32_32x32x16_bf16 v[64:79], v[160:163], a[96:99], v[64:79]
    v_mfma_f32_32x32x16_bf16 v[80:95], v[160:163], a[224:227], v[80:95]
    buffer_load_dwordx4 v[160:163], v210, s[44:47], s51 offen offset:2048 sc1
    s_waitcnt vmcnt(9)
    v_mfma_f32_32x32x16_bf16 v[96:111], v[164:167], a[96:99], v[96:111]
    v_mfma_f32_32x32x16_bf16 v[112:127], v[164:167], a[224:227], v[112:127]
    buffer_load_dwordx4 v[164:167], v211, s[44:47], s51 offen offset:2048 sc1
    s_waitcnt vmcnt(9)
    v_mfma_f32_32x32x16_bf16 v[64:79], v[128:131], a[100:103], v[64:79]
    v_mfma_f32_32x32x16_bf16 v[80:95], v[128:131], a[228:231], v[80:95]
    s_add_u32 s51, s51, 4096
    buffer_load_dwordx4 v[128:131], v210, s[44:47], s51 offen sc1
    s_waitcnt vmcnt(9)
    v_mfma_f32_32x32x16_bf16 v[96:111], v[132:135], a[100:103], v[96:111]
    v_mfma_f32_32x32x16_bf16 v[112:127], v[132:135], a[228:231], v[112:127]
    buffer_load_dwordx4 v[132:135], v211, s[44:47], s51 offen sc1
    s_waitcnt vmcnt(9)
    v_mfma_f32_32x32x16_bf16 v[64:79], v[136:139], a[104:107], v[64:79]
    v_mfma_f32_32x32x16_bf16 v[80:95], v[136:139], a[232:235], v[80:95]
    buffer_load_dwordx4 v[136:139], v210, s[44:47], s51 offen offset:2048 sc1
    s_waitcnt vmcnt(9)
    v_mfma_f32_32x32x16_bf16 v[96:111], v[140:143], a[104:107], v[96:111]
    v_mfma_f32_32x32x16_bf16 v[112:127], v[140:143], a[232:235], v[112:127]
    buffer_load_dwordx4 v[140:143], v211, s[44:47], s51 offen offset:2048 sc1
    s_waitcnt vmcnt(9)
    v_mfma_f32_32x32x16_bf16 v[64:79], v[144:147], a[108:111], v[64:79]
    v_mfma_f32_32x32x16_bf16 v[80:95], v[144:147], a[236:239], v[80:95]
    s_add_u32 s51, s51, 4096
    buffer_load_dwordx4 v[144:147], v210, s[44:47], s51 offen sc1
    s_waitcnt vmcnt(9)
    v_mfma_f32_32x32x16_bf16 v[96:111], v[148:151], a[108:111], v[96:111]
    v_mfma_f32_32x32x16_bf16 v[112:127], v[148:151], a[236:239], v[112:127]
    buffer_load_dwordx4 v[148:151], v211, s[44:47], s51 offen sc1
    s_waitcnt vmcnt(9)
    v_mfma_f32_32x32x16_bf16 v[0:15], v[152:155], a[112:115], 0
    v_mfma_f32_32x32x16_bf16 v[16:31], v[152:155], a[240:243], 0
    buffer_load_dwordx4 v[152:155], v210, s[44:47], s51 offen offset:2048 sc1
    s_waitcnt vmcnt(9)
    v_mfma_f32_32x32x16_bf16 v[32:47], v[156:159], a[112:115], 0
    v_mfma_f32_32x32x16_bf16 v[48:63], v[156:159], a[240:243], 0
    buffer_load_dwordx4 v[156:159], v211, s[44:47], s51 offen offset:2048 sc1
    s_waitcnt vmcnt(9)
    v_mfma_f32_32x32x16_bf16 v[0:15], v[160:163], a[116:119], v[0:15]
    v_mfma_f32_32x32x16_bf16 v[16:31], v[160:163], a[244:247], v[16:31]
    s_add_u32 s51, s51, 4096
    buffer_load_dwordx4 v[160:163], v210, s[44:47], s51 offen sc1
    s_waitcnt vmcnt(9)
    v_mfma_f32_32x32x16_bf16 v[32:47], v[164:167], a[116:119], v[32:47]
    v_mfma_f32_32x32x16_bf16 v[48:63], v[164:167], a[244:247], v[48:63]
    buffer_load_dwordx4 v[164:167], v211, s[44:47], s51 offen sc1
    s_waitcnt vmcnt(9)
    v_mfma_f32_32x32x16_bf16 v[0:15], v[128:131], a[120:123], v[0:15]
    ds_write_b128 v212, v[80:83] offset:0
    ds_write_b128 v212, v[84:87] offset:1024
    ds_write_b128 v212, v[88:91] offset:2048
    ds_write_b128 v212, v[92:95] offset:3072
    ds_write_b128 v213, v[96:99] offset:0
    ds_write_b128 v213, v[100:103] offset:1024
    v_mfma_f32_32x32x16_bf16 v[16:31], v[128:131], a[248:251], v[16:31]
    buffer_load_dwordx4 v[128:131], v210, s[44:47], s51 offen offset:2048 sc1
    ds_write_b128 v213, v[104:107] offset:2048
    ds_write_b128 v213, v[108:111] offset:3072
    ds_write_b128 v214, v[112:115] offset:0
    ds_write_b128 v214, v[116:119] offset:1024
    ds_write_b128 v214, v[120:123] offset:2048
    s_waitcnt vmcnt(9)
    v_mfma_f32_32x32x16_bf16 v[32:47], v[132:135], a[120:123], v[32:47]
    ds_write_b128 v214, v[124:127] offset:3072
    v_mfma_f32_32x32x16_bf16 v[48:63], v[132:135], a[248:251], v[48:63]
    buffer_load_dwordx4 v[132:135], v211, s[44:47], s51 offen offset:2048 sc1
    s_waitcnt vmcnt(9)
    v_mfma_f32_32x32x16_bf16 v[0:15], v[136:139], a[124:127], v[0:15]
    v_mfma_f32_32x32x16_bf16 v[16:31], v[136:139], a[252:255], v[16:31]
    s_add_u32 s51, s51, 4096
    buffer_load_dwordx4 v[136:139], v210, s[44:47], s51 offen sc1
    s_waitcnt vmcnt(9)
    v_mfma_f32_32x32x16_bf16 v[32:47], v[140:143], a[124:127], v[32:47]
    v_mfma_f32_32x32x16_bf16 v[48:63], v[140:143], a[252:255], v[48:63]
    buffer_load_dwordx4 v[140:143], v211, s[44:47], s51 offen sc1
    s_waitcnt vmcnt(9)
    v_mfma_f32_32x32x16_bf16 v[0:15], v[144:147], a[0:3], v[0:15]
    v_mfma_f32_32x32x16_bf16 v[16:31], v[144:147], a[128:131], v[16:31]
    buffer_load_dwordx4 v[144:147], v210, s[44:47], s51 offen offset:2048 sc1
    s_waitcnt vmcnt(9)
    v_mfma_f32_32x32x16_bf16 v[32:47], v[148:151], a[0:3], v[32:47]
    v_mfma_f32_32x32x16_bf16 v[48:63], v[148:151], a[128:131], v[48:63]
    buffer_load_dwordx4 v[148:151], v211, s[44:47], s51 offen offset:2048 sc1
    s_waitcnt lgkmcnt(0)
    s_barrier
    s_waitcnt vmcnt(9)
    v_mfma_f32_32x32x16_bf16 v[0:15], v[152:155], a[4:7], v[0:15]
    ds_read_b128 v[80:83], v215 offset:0
    ds_read_b128 v[96:99], v215 offset:4096
    ds_read_b128 v[112:115], v215 offset:8192
    ds_read_b128 v[84:87], v215 offset:1024
    ds_read_b128 v[100:103], v215 offset:5120
    ds_read_b128 v[116:119], v215 offset:9216
    v_mfma_f32_32x32x16_bf16 v[16:31], v[152:155], a[132:135], v[16:31]
    s_add_u32 s51, s51, 4096
    buffer_load_dwordx4 v[152:155], v210, s[44:47], s51 offen sc1
    ds_read_b128 v[88:91], v215 offset:2048
    ds_read_b128 v[104:107], v215 offset:6144
    ds_read_b128 v[120:123], v215 offset:10240
    ds_read_b128 v[92:95], v215 offset:3072
    ds_read_b128 v[108:111], v215 offset:7168
    s_waitcnt vmcnt(9)
    v_mfma_f32_32x32x16_bf16 v[32:47], v[156:159], a[4:7], v[32:47]
    ds_read_b128 v[124:127], v215 offset:11264
    v_mfma_f32_32x32x16_bf16 v[48:63], v[156:159], a[132:135], v[48:63]
    buffer_load_dwordx4 v[156:159], v211, s[44:47], s51 offen sc1
    s_waitcnt vmcnt(9)
    v_mfma_f32_32x32x16_bf16 v[0:15], v[160:163], a[8:11], v[0:15]
    s_waitcnt lgkmcnt(11)
    v_add_f32 v64, v64, v80
    v_add_f32 v65, v65, v81
    v_add_f32 v66, v66, v82
    v_add_f32 v67, v67, v83
    s_waitcnt lgkmcnt(8)
    v_add_f32 v68, v68, v84
    v_add_f32 v69, v69, v85
    v_mfma_f32_32x32x16_bf16 v[16:31], v[160:163], a[136:139], v[16:31]
    buffer_load_dwordx4 v[160:163], v210, s[44:47], s51 offen offset:2048 sc1
    v_add_f32 v70, v70, v86
    v_add_f32 v71, v71, v87
    s_waitcnt lgkmcnt(5)
    v_add_f32 v72, v72, v88
    v_add_f32 v73, v73, v89
    v_add_f32 v74, v74, v90
    s_waitcnt vmcnt(9)
    v_mfma_f32_32x32x16_bf16 v[32:47], v[164:167], a[8:11], v[32:47]
    v_add_f32 v75, v75, v91
    s_waitcnt lgkmcnt(2)
    v_add_f32 v76, v76, v92
    v_add_f32 v77, v77, v93
    v_add_f32 v78, v78, v94
    v_add_f32 v79, v79, v95
    v_add_f32 v64, v64, v96
    v_mfma_f32_32x32x16_bf16 v[48:63], v[164:167], a[136:139], v[48:63]
    buffer_load_dwordx4 v[164:167], v211, s[44:47], s51 offen offset:2048 sc1
    v_add_f32 v65, v65, v97
    v_add_f32 v66, v66, v98
    v_add_f32 v67, v67, v99
    v_add_f32 v68, v68, v100
    v_add_f32 v69, v69, v101
    s_waitcnt vmcnt(9)
    v_mfma_f32_32x32x16_bf16 v[0:15], v[128:131], a[12:15], v[0:15]
    v_add_f32 v70, v70, v102
    v_add_f32 v71, v71, v103
    v_add_f32 v72, v72, v104
    v_add_f32 v73, v73, v105
    v_add_f32 v74, v74, v106
    v_add_f32 v75, v75, v107
    v_mfma_f32_32x32x16_bf16 v[16:31], v[128:131], a[140:143], v[16:31]
    s_add_u32 s51, s51, 4096
    buffer_load_dwordx4 v[128:131], v210, s[44:47], s51 offen sc1
    s_waitcnt lgkmcnt(1)
    v_add_f32 v76, v76, v108
    v_add_f32 v77, v77, v109
    v_add_f32 v78, v78, v110
    v_add_f32 v79, v79, v111
    v_add_f32 v64, v64, v112
    s_waitcnt vmcnt(9)
    v_mfma_f32_32x32x16_bf16 v[32:47], v[132:135], a[12:15], v[32:47]
    v_add_f32 v65, v65, v113
    v_add_f32 v66, v66, v114
    v_add_f32 v67, v67, v115
    v_add_f32 v68, v68, v116
    v_add_f32 v69, v69, v117
    v_add_f32 v70, v70, v118
    v_mfma_f32_32x32x16_bf16 v[48:63], v[132:135], a[140:143], v[48:63]
    buffer_load_dwordx4 v[132:135], v211, s[44:47], s51 offen sc1
    v_add_f32 v71, v71, v119
    v_add_f32 v72, v72, v120
    v_add_f32 v73, v73, v121
    v_add_f32 v74, v74, v122
    v_add_f32 v75, v75, v123
    s_waitcnt vmcnt(9)
    v_mfma_f32_32x32x16_bf16 v[0:15], v[136:139], a[16:19], v[0:15]
    s_waitcnt lgkmcnt(0)
    v_add_f32 v76, v76, v124
    v_add_f32 v77, v77, v125
    v_add_f32 v78, v78, v126
    v_add_f32 v79, v79, v127
    v_mul_f32 v232, v232, v220
    v_mul_f32 v233, v233, v220
    v_mfma_f32_32x32x16_bf16 v[16:31], v[136:139], a[144:147], v[16:31]
    buffer_load_dwordx4 v[136:139], v210, s[44:47], s51 offen offset:2048 sc1
    v_cvt_pk_bf16_f32 v226, v64, v65
    v_cvt_pk_bf16_f32 v233, v232, v233
    v_lshlrev_b32 v64, 16, v226
    v_and_b32 v65, 0xffff0000, v226
    v_and_b32 v227, 0xffff0000, v184
    s_waitcnt vmcnt(9)
    v_mfma_f32_32x32x16_bf16 v[32:47], v[140:143], a[16:19], v[32:47]
    v_and_b32 v228, 0xffff0000, v185
    v_lshlrev_b32 v232, 16, v233
    v_and_b32 v233, 0xffff0000, v233
    v_mul_f32 v227, v227, v64
    v_mul_f32 v228, v228, v65
    v_lshlrev_b32 v184, 16, v184
    v_mfma_f32_32x32x16_bf16 v[48:63], v[140:143], a[144:147], v[48:63]
    buffer_load_dwordx4 v[140:143], v211, s[44:47], s51 offen offset:2048 sc1
    v_lshlrev_b32 v185, 16, v185
    v_cvt_pk_bf16_f32 v226, v227, v228
    v_lshlrev_b32 v64, 16, v226
    v_and_b32 v65, 0xffff0000, v226
    v_fma_f32 v64, v184, v232, v64
    s_waitcnt vmcnt(9)
    v_mfma_f32_32x32x16_bf16 v[0:15], v[144:147], a[20:23], v[0:15]
    v_fma_f32 v65, v185, v233, v65
    v_add_f32 v184, v184, v184
    v_add_f32 v185, v185, v185
    v_mul_f32 v234, v234, v220
    v_mul_f32 v235, v235, v220
    v_cvt_pk_bf16_f32 v229, v66, v67
    v_mfma_f32_32x32x16_bf16 v[16:31], v[144:147], a[148:151], v[16:31]
    s_add_u32 s51, s51, 4096
    buffer_load_dwordx4 v[144:147], v210, s[44:47], s51 offen sc1
    v_cvt_pk_bf16_f32 v235, v234, v235
    v_lshlrev_b32 v66, 16, v229
    v_and_b32 v67, 0xffff0000, v229
    v_and_b32 v230, 0xffff0000, v186
    v_and_b32 v231, 0xffff0000, v187
    s_waitcnt vmcnt(9)
    v_mfma_f32_32x32x16_bf16 v[32:47], v[148:151], a[20:23], v[32:47]
    v_lshlrev_b32 v234, 16, v235
    v_and_b32 v235, 0xffff0000, v235
    v_mul_f32 v230, v230, v66
    v_mul_f32 v231, v231, v67
    v_lshlrev_b32 v186, 16, v186
    v_lshlrev_b32 v187, 16, v187
    v_mfma_f32_32x32x16_bf16 v[48:63], v[148:151], a[148:151], v[48:63]
    buffer_load_dwordx4 v[148:151], v211, s[44:47], s51 offen sc1
    v_cvt_pk_bf16_f32 v229, v230, v231
    v_lshlrev_b32 v66, 16, v229
    v_and_b32 v67, 0xffff0000, v229
    v_fma_f32 v66, v186, v234, v66
    v_fma_f32 v67, v187, v235, v67
    s_waitcnt vmcnt(9)
    v_mfma_f32_32x32x16_bf16 v[0:15], v[152:155], a[24:27], v[0:15]
    v_add_f32 v186, v186, v186
    v_add_f32 v187, v187, v187
    v_mul_f32 v236, v236, v220
    v_mul_f32 v237, v237, v220
    v_cvt_pk_bf16_f32 v226, v68, v69
    v_cvt_pk_bf16_f32 v237, v236, v237
    v_mfma_f32_32x32x16_bf16 v[16:31], v[152:155], a[152:155], v[16:31]
    buffer_load_dwordx4 v[152:155], v210, s[44:47], s51 offen offset:2048 sc1
    v_lshlrev_b32 v68, 16, v226
    v_and_b32 v69, 0xffff0000, v226
    v_and_b32 v227, 0xffff0000, v188
    v_and_b32 v228, 0xffff0000, v189
    v_lshlrev_b32 v236, 16, v237
    s_waitcnt vmcnt(9)
    v_mfma_f32_32x32x16_bf16 v[32:47], v[156:159], a[24:27], v[32:47]
    v_and_b32 v237, 0xffff0000, v237
    v_mul_f32 v227, v227, v68
    v_mul_f32 v228, v228, v69
    v_lshlrev_b32 v188, 16, v188
    v_lshlrev_b32 v189, 16, v189
    v_cvt_pk_bf16_f32 v226, v227, v228
    v_mfma_f32_32x32x16_bf16 v[48:63], v[156:159], a[152:155], v[48:63]
    buffer_load_dwordx4 v[156:159], v211, s[44:47], s51 offen offset:2048 sc1
    v_lshlrev_b32 v68, 16, v226
    v_and_b32 v69, 0xffff0000, v226
    v_fma_f32 v68, v188, v236, v68
    v_fma_f32 v69, v189, v237, v69
    v_add_f32 v188, v188, v188
    s_waitcnt vmcnt(9)
    v_mfma_f32_32x32x16_bf16 v[0:15], v[160:163], a[28:31], v[0:15]
    v_add_f32 v189, v189, v189
    v_mul_f32 v238, v238, v220
    v_mul_f32 v239, v239, v220
    v_cvt_pk_bf16_f32 v229, v70, v71
    v_cvt_pk_bf16_f32 v239, v238, v239
    v_lshlrev_b32 v70, 16, v229
    v_mfma_f32_32x32x16_bf16 v[16:31], v[160:163], a[156:159], v[16:31]
    v_and_b32 v71, 0xffff0000, v229
    v_and_b32 v230, 0xffff0000, v190
    v_and_b32 v231, 0xffff0000, v191
    v_lshlrev_b32 v238, 16, v239
    v_and_b32 v239, 0xffff0000, v239
    v_mul_f32 v230, v230, v70
    s_waitcnt vmcnt(8)
    v_mfma_f32_32x32x16_bf16 v[32:47], v[164:167], a[28:31], v[32:47]
    v_mul_f32 v231, v231, v71
    v_lshlrev_b32 v190, 16, v190
    v_lshlrev_b32 v191, 16, v191
    v_cvt_pk_bf16_f32 v229, v230, v231
    v_lshlrev_b32 v70, 16, v229
    v_and_b32 v71, 0xffff0000, v229
    v_mfma_f32_32x32x16_bf16 v[48:63], v[164:167], a[156:159], v[48:63]
    v_fma_f32 v70, v190, v238, v70
    v_fma_f32 v71, v191, v239, v71
    v_add_f32 v190, v190, v190
    v_add_f32 v191, v191, v191
    v_mul_f32 v240, v240, v220
    v_mul_f32 v241, v241, v220
    s_waitcnt vmcnt(7)
    v_mfma_f32_32x32x16_bf16 v[0:15], v[128:131], a[32:35], v[0:15]
    v_cvt_pk_bf16_f32 v226, v72, v73
    v_cvt_pk_bf16_f32 v241, v240, v241
    v_lshlrev_b32 v72, 16, v226
    v_and_b32 v73, 0xffff0000, v226
    v_and_b32 v227, 0xffff0000, v192
    v_and_b32 v228, 0xffff0000, v193
    v_mfma_f32_32x32x16_bf16 v[16:31], v[128:131], a[160:163], v[16:31]
    v_lshlrev_b32 v240, 16, v241
    v_and_b32 v241, 0xffff0000, v241
    v_mul_f32 v227, v227, v72
    v_mul_f32 v228, v228, v73
    v_lshlrev_b32 v192, 16, v192
    v_lshlrev_b32 v193, 16, v193
    s_waitcnt vmcnt(6)
    v_mfma_f32_32x32x16_bf16 v[32:47], v[132:135], a[32:35], v[32:47]
    v_cvt_pk_bf16_f32 v226, v227, v228
    v_lshlrev_b32 v72, 16, v226
    v_and_b32 v73, 0xffff0000, v226
    v_fma_f32 v72, v192, v240, v72
    v_fma_f32 v73, v193, v241, v73
    v_add_f32 v192, v192, v192
    v_mfma_f32_32x32x16_bf16 v[48:63], v[132:135], a[160:163], v[48:63]
    v_add_f32 v193, v193, v193
    v_mul_f32 v242, v242, v220
    v_mul_f32 v243, v243, v220
    v_cvt_pk_bf16_f32 v229, v74, v75
    v_cvt_pk_bf16_f32 v243, v242, v243
    v_lshlrev_b32 v74, 16, v229
    s_waitcnt vmcnt(5)
    v_mfma_f32_32x32x16_bf16 v[0:15], v[136:139], a[36:39], v[0:15]
    v_and_b32 v75, 0xffff0000, v229
    v_and_b32 v230, 0xffff0000, v194
    v_and_b32 v231, 0xffff0000, v195
    v_lshlrev_b32 v242, 16, v243
    v_and_b32 v243, 0xffff0000, v243
    v_mul_f32 v230, v230, v74
    v_mfma_f32_32x32x16_bf16 v[16:31], v[136:139], a[164:167], v[16:31]
    v_mul_f32 v231, v231, v75
    v_lshlrev_b32 v194, 16, v194
    v_lshlrev_b32 v195, 16, v195
    v_cvt_pk_bf16_f32 v229, v230, v231
    v_lshlrev_b32 v74, 16, v229
    v_and_b32 v75, 0xffff0000, v229
    s_waitcnt vmcnt(4)
    v_mfma_f32_32x32x16_bf16 v[32:47], v[140:143], a[36:39], v[32:47]
    v_fma_f32 v74, v194, v242, v74
    v_fma_f32 v75, v195, v243, v75
    v_add_f32 v194, v194, v194
    v_add_f32 v195, v195, v195
    v_mul_f32 v244, v244, v220
    v_mul_f32 v245, v245, v220
    v_mfma_f32_32x32x16_bf16 v[48:63], v[140:143], a[164:167], v[48:63]
    v_cvt_pk_bf16_f32 v226, v76, v77
    v_cvt_pk_bf16_f32 v245, v244, v245
    v_lshlrev_b32 v76, 16, v226
    v_and_b32 v77, 0xffff0000, v226
    v_and_b32 v227, 0xffff0000, v196
    v_and_b32 v228, 0xffff0000, v197
    s_waitcnt vmcnt(3)
    v_mfma_f32_32x32x16_bf16 v[0:15], v[144:147], a[40:43], v[0:15]
    v_lshlrev_b32 v244, 16, v245
    v_and_b32 v245, 0xffff0000, v245
    v_mul_f32 v227, v227, v76
    v_mul_f32 v228, v228, v77
    v_lshlrev_b32 v196, 16, v196
    v_lshlrev_b32 v197, 16, v197
    v_mfma_f32_32x32x16_bf16 v[16:31], v[144:147], a[168:171], v[16:31]
    v_cvt_pk_bf16_f32 v226, v227, v228
    v_lshlrev_b32 v76, 16, v226
    v_and_b32 v77, 0xffff0000, v226
    v_fma_f32 v76, v196, v244, v76
    v_fma_f32 v77, v197, v245, v77
    v_add_f32 v196, v196, v196
    s_waitcnt vmcnt(2)
    v_mfma_f32_32x32x16_bf16 v[32:47], v[148:151], a[40:43], v[32:47]
    v_add_f32 v197, v197, v197
    v_mul_f32 v246, v246, v220
    v_mul_f32 v247, v247, v220
    v_cvt_pk_bf16_f32 v229, v78, v79
    v_cvt_pk_bf16_f32 v247, v246, v247
    v_lshlrev_b32 v78, 16, v229
    v_mfma_f32_32x32x16_bf16 v[48:63], v[148:151], a[168:171], v[48:63]
    v_and_b32 v79, 0xffff0000, v229
    v_and_b32 v230, 0xffff0000, v198
    v_and_b32 v231, 0xffff0000, v199
    v_lshlrev_b32 v246, 16, v247
    v_and_b32 v247, 0xffff0000, v247
    v_mul_f32 v230, v230, v78
    s_waitcnt vmcnt(1)
    v_mfma_f32_32x32x16_bf16 v[0:15], v[152:155], a[44:47], v[0:15]
    v_mul_f32 v231, v231, v79
    v_lshlrev_b32 v198, 16, v198
    v_lshlrev_b32 v199, 16, v199
    v_cvt_pk_bf16_f32 v229, v230, v231
    v_lshlrev_b32 v78, 16, v229
    v_and_b32 v79, 0xffff0000, v229
    v_mfma_f32_32x32x16_bf16 v[16:31], v[152:155], a[172:175], v[16:31]
    v_fma_f32 v78, v198, v246, v78
    v_fma_f32 v79, v199, v247, v79
    v_add_f32 v198, v198, v198
    v_add_f32 v199, v199, v199
    s_waitcnt vmcnt(0)
    v_mfma_f32_32x32x16_bf16 v[32:47], v[156:159], a[44:47], v[32:47]
    v_mfma_f32_32x32x16_bf16 v[48:63], v[156:159], a[172:175], v[48:63]
    s_nop 4
    ds_write_b128 v212, v[16:19] offset:49152
    ds_write_b128 v212, v[20:23] offset:50176
    ds_write_b128 v212, v[24:27] offset:51200
    ds_write_b128 v212, v[28:31] offset:52224
    s_nop 1
    ds_write_b128 v213, v[32:35] offset:49152
    ds_write_b128 v213, v[36:39] offset:50176
    ds_write_b128 v213, v[40:43] offset:51200
    ds_write_b128 v213, v[44:47] offset:52224
    ds_write_b128 v214, v[48:51] offset:49152
    ds_write_b128 v214, v[52:55] offset:50176
    ds_write_b128 v214, v[56:59] offset:51200
    ds_write_b128 v214, v[60:63] offset:52224
    s_waitcnt lgkmcnt(0)
    s_barrier
    ds_read_b128 v[80:83], v215 offset:49152
    ds_read_b128 v[96:99], v215 offset:53248
    ds_read_b128 v[112:115], v215 offset:57344
    ds_read_b128 v[84:87], v215 offset:50176
    ds_read_b128 v[100:103], v215 offset:54272
    ds_read_b128 v[116:119], v215 offset:58368
    ds_read_b128 v[88:91], v215 offset:51200
    ds_read_b128 v[104:107], v215 offset:55296
    ds_read_b128 v[120:123], v215 offset:59392
    ds_read_b128 v[92:95], v215 offset:52224
    ds_read_b128 v[108:111], v215 offset:56320
    ds_read_b128 v[124:127], v215 offset:60416
    s_waitcnt lgkmcnt(11)
    v_pk_add_f32 v[0:1], v[0:1], v[80:81]
    v_pk_add_f32 v[2:3], v[2:3], v[82:83]
    s_waitcnt lgkmcnt(10)
    v_pk_add_f32 v[0:1], v[0:1], v[96:97]
    v_pk_add_f32 v[2:3], v[2:3], v[98:99]
    s_waitcnt lgkmcnt(9)
    v_pk_add_f32 v[0:1], v[0:1], v[112:113]
    v_pk_add_f32 v[2:3], v[2:3], v[114:115]
    v_fma_f32 v0, v184, v0, v64
    v_fma_f32 v1, v185, v1, v65
    v_fma_f32 v2, v186, v2, v66
    v_fma_f32 v3, v187, v3, v67
    buffer_store_dword v0, v217, s[36:39], 0 offen sc1
    buffer_store_dword v1, v217, s[36:39], 0 offen offset:2048 sc1
    s_mov_b32 s70, 4096
    buffer_store_dword v2, v217, s[36:39], s70 offen sc1
    buffer_store_dword v3, v217, s[36:39], s70 offen offset:2048 sc1
    s_waitcnt lgkmcnt(8)
    v_pk_add_f32 v[4:5], v[4:5], v[84:85]
    v_pk_add_f32 v[6:7], v[6:7], v[86:87]
    s_waitcnt lgkmcnt(7)
    v_pk_add_f32 v[4:5], v[4:5], v[100:101]
    v_pk_add_f32 v[6:7], v[6:7], v[102:103]
    s_waitcnt lgkmcnt(6)
    v_pk_add_f32 v[4:5], v[4:5], v[116:117]
    v_pk_add_f32 v[6:7], v[6:7], v[118:119]
    v_fma_f32 v4, v188, v4, v68
    v_fma_f32 v5, v189, v5, v69
    v_fma_f32 v6, v190, v6, v70
    v_fma_f32 v7, v191, v7, v71
    s_mov_b32 s70, 16384
    buffer_store_dword v4, v217, s[36:39], s70 offen sc1
    buffer_store_dword v5, v217, s[36:39], s70 offen offset:2048 sc1
    s_mov_b32 s70, 20480
    buffer_store_dword v6, v217, s[36:39], s70 offen sc1
    buffer_store_dword v7, v217, s[36:39], s70 offen offset:2048 sc1
    s_waitcnt lgkmcnt(5)
    v_pk_add_f32 v[8:9], v[8:9], v[88:89]
    v_pk_add_f32 v[10:11], v[10:11], v[90:91]
    s_waitcnt lgkmcnt(4)
    v_pk_add_f32 v[8:9], v[8:9], v[104:105]
    v_pk_add_f32 v[10:11], v[10:11], v[106:107]
    s_waitcnt lgkmcnt(3)
    v_pk_add_f32 v[8:9], v[8:9], v[120:121]
    v_pk_add_f32 v[10:11], v[10:11], v[122:123]
    v_fma_f32 v8, v192, v8, v72
    v_fma_f32 v9, v193, v9, v73
    v_fma_f32 v10, v194, v10, v74
    v_fma_f32 v11, v195, v11, v75
    s_mov_b32 s70, 32768
    buffer_store_dword v8, v217, s[36:39], s70 offen sc1
    buffer_store_dword v9, v217, s[36:39], s70 offen offset:2048 sc1
    s_mov_b32 s70, 36864
    buffer_store_dword v10, v217, s[36:39], s70 offen sc1
    buffer_store_dword v11, v217, s[36:39], s70 offen offset:2048 sc1
    s_waitcnt lgkmcnt(2)
    v_pk_add_f32 v[12:13], v[12:13], v[92:93]
    v_pk_add_f32 v[14:15], v[14:15], v[94:95]
    s_waitcnt lgkmcnt(1)
    v_pk_add_f32 v[12:13], v[12:13], v[108:109]
    v_pk_add_f32 v[14:15], v[14:15], v[110:111]
    s_waitcnt lgkmcnt(0)
    v_pk_add_f32 v[12:13], v[12:13], v[124:125]
    v_pk_add_f32 v[14:15], v[14:15], v[126:127]
    v_fma_f32 v12, v196, v12, v76
    v_fma_f32 v13, v197, v13, v77
    v_fma_f32 v14, v198, v14, v78
    v_fma_f32 v15, v199, v15, v79
    s_mov_b32 s70, 49152
    buffer_store_dword v12, v217, s[36:39], s70 offen sc1
    buffer_store_dword v13, v217, s[36:39], s70 offen offset:2048 sc1
    s_mov_b32 s70, 53248
    buffer_store_dword v14, v217, s[36:39], s70 offen sc1
    buffer_store_dword v15, v217, s[36:39], s70 offen offset:2048 sc1
fused_kernel_end:
    s_endpgm
fused_kernel_codeend:
.section .rodata,"a"
.p2align 6
.amdhsa_kernel fused_kernel
  .amdhsa_next_free_vgpr 512
  .amdhsa_next_free_sgpr 102
  .amdhsa_accum_offset 256
  .amdhsa_group_segment_fixed_size 0
  .amdhsa_float_denorm_mode_32 3
  .amdhsa_kernarg_size 136
  .amdhsa_user_sgpr_count 2
  .amdhsa_user_sgpr_kernarg_segment_ptr 1
  .amdhsa_system_sgpr_workgroup_id_x 1
.end_amdhsa_kernel
```
